```python
import torch

def _softmax(x, axis=-1):
    return torch.softmax(x, dim=axis)
def _gelu(x):
    return torch.nn.functional.gelu(x, approximate="tanh")
def _silu(x):
    return torch.nn.functional.silu(x)
def _sigmoid(x):
    return torch.sigmoid(x)
def _layernorm(x, axis=-1, eps=1e-5):
    m = x.mean(dim=axis, keepdim=True)
    v = x.var(dim=axis, keepdim=True, unbiased=False)
    return (x - m) / torch.sqrt(v + eps)
def _scatter_add(tgt, idx, src, axis=0):
    return tgt.clone().index_add_(axis, idx, src)
def _segment_sum(src, seg, n):
    out = torch.zeros((n,) + src.shape[1:], dtype=src.dtype)
    return out.index_add_(0, seg, src)
def _pad(x, pw):
    flat = tuple(v for pair in reversed(pw) for v in pair)
    return torch.nn.functional.pad(x, flat)

kernel_name = 'concat_heads__mha_block_cached__compressed_kv_cla__decode'

def setup_inputs():

    _w = (lambda a: (lambda t: t.to(torch.bfloat16) if t.is_floating_point() else t)(torch.as_tensor(a)))
    def _A_setup():
        B, Sq, D = 1, 1, 640
        H, Sk, Dh = 32, 8192, 192
        return {
            "x": _w((lambda *s: torch.randn(*s, dtype=torch.bfloat16) * 1.6)(B, Sq, D)),
            "k_cache": _w((lambda *s: torch.randn(*s, dtype=torch.bfloat16) * 1.6)(B, H, Sk, Dh)),
            "v_cache": _w((lambda *s: torch.randn(*s, dtype=torch.bfloat16) * 0.05)(B, H, Sk, Dh)),
            "wq": _w((lambda *s: torch.randn(*s, dtype=torch.bfloat16) * 1.6)(D, H * Dh) * (D ** -0.5)),
            "wo": _w((lambda *s: torch.randn(*s, dtype=torch.bfloat16) * 0.05)(H * Dh, D) * ((H * Dh) ** -0.5)),
        }
    _A_in = _A_setup()

    def _B_setup():
        B, H, Sq, Sk, D, M = 1, 32, 1, 8192, 192, 640
        Dc = 4 * D
        return {
            "x": _w((lambda *s: torch.randn(*s, dtype=torch.bfloat16) * 3.2)(B, Sq, M)),
            "c_kv": _w((lambda *s: torch.randn(*s, dtype=torch.bfloat16) * 0.1)(B, Sk, Dc)),
            "w_q": _w((lambda *s: torch.randn(*s, dtype=torch.bfloat16) * 6.4)(M, H, D) * (M ** -0.5)),
            "w_uk": _w((lambda *s: torch.randn(*s, dtype=torch.bfloat16) * 6.4)(Dc, H, D) * (Dc ** -0.5)),
            "w_uv": _w((lambda *s: torch.randn(*s, dtype=torch.bfloat16) * 0.1)(Dc, H, D) * (Dc ** -0.5)),
            "w_o": _w((lambda *s: torch.randn(*s, dtype=torch.bfloat16) * 0.1)(H, D, M) * ((H * D) ** -0.5)),
        }
    _B_in = _B_setup()

    return {
        "A_x": _A_in["x"],
        "A_k_cache": _A_in["k_cache"],
        "A_v_cache": _A_in["v_cache"],
        "A_wq": _A_in["wq"],
        "A_wo": _A_in["wo"],
        "B_x": _B_in["x"],
        "B_c_kv": _B_in["c_kv"],
        "B_w_q": _B_in["w_q"],
        "B_w_uk": _B_in["w_uk"],
        "B_w_uv": _B_in["w_uv"],
        "B_w_o": _B_in["w_o"],
    }

def reference(A_x, A_k_cache, A_v_cache, A_wq, A_wo, B_x, B_c_kv, B_w_q, B_w_uk, B_w_uv, B_w_o):
    def _A_ref(x, k_cache, v_cache, wq, wo):
        B, Sq, D = x.shape
        H, Dh = 32, 192
        q = (lambda x, *d: x.permute(*d))((x @ wq).reshape(B, Sq, H, Dh), 0, 2, 1, 3)
        scores = torch.einsum("bhqd,bhkd->bhqk", q, k_cache) * (Dh ** -0.5)
        p = _softmax(scores, axis=-1)
        o = torch.einsum("bhqk,bhkd->bhqd", p, v_cache)
        return (lambda x, *d: x.permute(*d))(o, 0, 2, 1, 3).reshape(B, Sq, H * Dh) @ wo

    def _B_ref(x, c_kv, w_q, w_uk, w_uv, w_o):
        B, Sq, M = x.shape[0], x.shape[1], x.shape[2]
        Sk = c_kv.shape[1]
        H, D = w_q.shape[1], w_q.shape[2]
        q = torch.einsum("bqm,mhd->bhqd", x, w_q)
        k = torch.einsum("bkc,chd->bhkd", c_kv, w_uk)
        v = torch.einsum("bkc,chd->bhkd", c_kv, w_uv)
        scores = torch.einsum("bhqd,bhkd->bhqk", q, k) * (D ** -0.5)
        off = Sk - Sq
        qi = torch.arange(Sq)[:, None]
        kj = torch.arange(Sk)[None, :]
        cmask = kj <= (qi + off)
        scores = torch.where(cmask[None, None], scores, -1e9)
        p = _softmax(scores, axis=-1)
        ctx = torch.einsum("bhqk,bhkd->bhqd", p, v)
        return torch.einsum("bhqd,hdm->bqm", ctx, w_o)

    a = _A_ref(A_x, A_k_cache, A_v_cache, A_wq, A_wo)
    b = _B_ref(B_x, B_c_kv, B_w_q, B_w_uk, B_w_uv, B_w_o)
    return torch.concatenate([a, b], axis=-1)
```

```asm
; @launch kernel=qproj_kernel grid=(384,1,1) block=(256,1,1) lds=16384
; @launch kernel=qabs_kernel grid=(384,1,1) block=(256,1,1) lds=0
; @launch kernel=attn_kernel grid=(288,1,1) block=(256,1,1) lds=57344
; @launch kernel=comb_kernel grid=(224,1,1) block=(256,1,1) lds=16384
; @launch kernel=oproj_kernel grid=(160,1,1) block=(256,1,1) lds=16384
; @launch kernel=final_kernel grid=(5,1,1) block=(256,1,1) lds=0
.amdgcn_target "amdgcn-amd-amdhsa--gfx950"
.text
.p2align 8
.type qproj_kernel,@function
qproj_kernel:
    s_cmp_ge_u32 s2, 384
    s_cbranch_scc1 K1_END
    s_cmp_ge_u32 s2, 192
    s_cbranch_scc1 K1_B
    s_load_dwordx2 s[4:5], s[0:1], 0
    s_load_dwordx2 s[8:9], s[0:1], 24
    s_mov_b32 s20, s2
    s_mov_b32 s21, 0
    s_branch K1_GO
K1_B:
    s_load_dwordx2 s[4:5], s[0:1], 40
    s_load_dwordx2 s[8:9], s[0:1], 56
    s_sub_u32 s20, s2, 192
    s_mov_b32 s21, 16384
K1_GO:
    s_load_dwordx2 s[12:13], s[0:1], 104
    s_mov_b32 s6, 1280
    s_mov_b32 s7, 0x00020000
    s_mov_b32 s10, 7864320
    s_mov_b32 s11, 0x00020000
    s_mov_b32 s14, 402653184
    s_mov_b32 s15, 0x00020000
    s_waitcnt lgkmcnt(0)
    v_lshlrev_b32 v1, 1, v0
    buffer_load_ushort v2, v1, s[4:7], 0 offen offset:0
    buffer_load_ushort v3, v1, s[4:7], 0 offen offset:512
    buffer_load_ushort v4, v1, s[4:7], 0 offen offset:1024
    v_lshlrev_b32 v5, 2, v0
    s_waitcnt vmcnt(0)
    v_lshlrev_b32 v2, 16, v2
    ds_write_b32 v5, v2 offset:0
    v_lshlrev_b32 v3, 16, v3
    ds_write_b32 v5, v3 offset:1024
    v_lshlrev_b32 v4, 16, v4
    ds_write_b32 v5, v4 offset:2048
    s_waitcnt lgkmcnt(0)
    s_barrier
    v_lshrrev_b32 v6, 2, v0
    v_lshlrev_b32 v7, 2, v6
    s_mov_b32 s22, 12288
    v_mul_lo_u32 v8, v6, s22
    v_and_b32 v9, 3, v0
    v_lshlrev_b32 v9, 4, v9
    v_add_u32 v8, v8, v9
    s_lshl_b32 s23, s20, 6
    v_add_u32 v8, s23, v8
    s_mov_b32 s24, 0
    buffer_load_dwordx4 v[32:35], v8, s[8:11], s24 offen
    s_add_u32 s24, s24, 786432
    buffer_load_dwordx4 v[36:39], v8, s[8:11], s24 offen
    s_add_u32 s24, s24, 786432
    buffer_load_dwordx4 v[40:43], v8, s[8:11], s24 offen
    s_add_u32 s24, s24, 786432
    buffer_load_dwordx4 v[44:47], v8, s[8:11], s24 offen
    s_add_u32 s24, s24, 786432
    buffer_load_dwordx4 v[48:51], v8, s[8:11], s24 offen
    s_add_u32 s24, s24, 786432
    buffer_load_dwordx4 v[52:55], v8, s[8:11], s24 offen
    s_add_u32 s24, s24, 786432
    buffer_load_dwordx4 v[56:59], v8, s[8:11], s24 offen
    s_add_u32 s24, s24, 786432
    buffer_load_dwordx4 v[60:63], v8, s[8:11], s24 offen
    s_add_u32 s24, s24, 786432
    buffer_load_dwordx4 v[64:67], v8, s[8:11], s24 offen
    s_add_u32 s24, s24, 786432
    buffer_load_dwordx4 v[68:71], v8, s[8:11], s24 offen
    v_mov_b32 v16, 0
    v_mov_b32 v17, 0
    v_mov_b32 v18, 0
    v_mov_b32 v19, 0
    v_mov_b32 v20, 0
    v_mov_b32 v21, 0
    v_mov_b32 v22, 0
    v_mov_b32 v23, 0
    ds_read_b32 v72, v7 offset:0
    s_waitcnt vmcnt(9) lgkmcnt(0)
    v_lshlrev_b32 v73, 16, v32
    v_and_b32 v74, 0xffff0000, v32
    v_fmac_f32 v16, v72, v73
    v_fmac_f32 v17, v72, v74
    v_lshlrev_b32 v73, 16, v33
    v_and_b32 v74, 0xffff0000, v33
    v_fmac_f32 v18, v72, v73
    v_fmac_f32 v19, v72, v74
    v_lshlrev_b32 v73, 16, v34
    v_and_b32 v74, 0xffff0000, v34
    v_fmac_f32 v20, v72, v73
    v_fmac_f32 v21, v72, v74
    v_lshlrev_b32 v73, 16, v35
    v_and_b32 v74, 0xffff0000, v35
    v_fmac_f32 v22, v72, v73
    v_fmac_f32 v23, v72, v74
    ds_read_b32 v72, v7 offset:256
    s_waitcnt vmcnt(8) lgkmcnt(0)
    v_lshlrev_b32 v73, 16, v36
    v_and_b32 v74, 0xffff0000, v36
    v_fmac_f32 v16, v72, v73
    v_fmac_f32 v17, v72, v74
    v_lshlrev_b32 v73, 16, v37
    v_and_b32 v74, 0xffff0000, v37
    v_fmac_f32 v18, v72, v73
    v_fmac_f32 v19, v72, v74
    v_lshlrev_b32 v73, 16, v38
    v_and_b32 v74, 0xffff0000, v38
    v_fmac_f32 v20, v72, v73
    v_fmac_f32 v21, v72, v74
    v_lshlrev_b32 v73, 16, v39
    v_and_b32 v74, 0xffff0000, v39
    v_fmac_f32 v22, v72, v73
    v_fmac_f32 v23, v72, v74
    ds_read_b32 v72, v7 offset:512
    s_waitcnt vmcnt(7) lgkmcnt(0)
    v_lshlrev_b32 v73, 16, v40
    v_and_b32 v74, 0xffff0000, v40
    v_fmac_f32 v16, v72, v73
    v_fmac_f32 v17, v72, v74
    v_lshlrev_b32 v73, 16, v41
    v_and_b32 v74, 0xffff0000, v41
    v_fmac_f32 v18, v72, v73
    v_fmac_f32 v19, v72, v74
    v_lshlrev_b32 v73, 16, v42
    v_and_b32 v74, 0xffff0000, v42
    v_fmac_f32 v20, v72, v73
    v_fmac_f32 v21, v72, v74
    v_lshlrev_b32 v73, 16, v43
    v_and_b32 v74, 0xffff0000, v43
    v_fmac_f32 v22, v72, v73
    v_fmac_f32 v23, v72, v74
    ds_read_b32 v72, v7 offset:768
    s_waitcnt vmcnt(6) lgkmcnt(0)
    v_lshlrev_b32 v73, 16, v44
    v_and_b32 v74, 0xffff0000, v44
    v_fmac_f32 v16, v72, v73
    v_fmac_f32 v17, v72, v74
    v_lshlrev_b32 v73, 16, v45
    v_and_b32 v74, 0xffff0000, v45
    v_fmac_f32 v18, v72, v73
    v_fmac_f32 v19, v72, v74
    v_lshlrev_b32 v73, 16, v46
    v_and_b32 v74, 0xffff0000, v46
    v_fmac_f32 v20, v72, v73
    v_fmac_f32 v21, v72, v74
    v_lshlrev_b32 v73, 16, v47
    v_and_b32 v74, 0xffff0000, v47
    v_fmac_f32 v22, v72, v73
    v_fmac_f32 v23, v72, v74
    ds_read_b32 v72, v7 offset:1024
    s_waitcnt vmcnt(5) lgkmcnt(0)
    v_lshlrev_b32 v73, 16, v48
    v_and_b32 v74, 0xffff0000, v48
    v_fmac_f32 v16, v72, v73
    v_fmac_f32 v17, v72, v74
    v_lshlrev_b32 v73, 16, v49
    v_and_b32 v74, 0xffff0000, v49
    v_fmac_f32 v18, v72, v73
    v_fmac_f32 v19, v72, v74
    v_lshlrev_b32 v73, 16, v50
    v_and_b32 v74, 0xffff0000, v50
    v_fmac_f32 v20, v72, v73
    v_fmac_f32 v21, v72, v74
    v_lshlrev_b32 v73, 16, v51
    v_and_b32 v74, 0xffff0000, v51
    v_fmac_f32 v22, v72, v73
    v_fmac_f32 v23, v72, v74
    ds_read_b32 v72, v7 offset:1280
    s_waitcnt vmcnt(4) lgkmcnt(0)
    v_lshlrev_b32 v73, 16, v52
    v_and_b32 v74, 0xffff0000, v52
    v_fmac_f32 v16, v72, v73
    v_fmac_f32 v17, v72, v74
    v_lshlrev_b32 v73, 16, v53
    v_and_b32 v74, 0xffff0000, v53
    v_fmac_f32 v18, v72, v73
    v_fmac_f32 v19, v72, v74
    v_lshlrev_b32 v73, 16, v54
    v_and_b32 v74, 0xffff0000, v54
    v_fmac_f32 v20, v72, v73
    v_fmac_f32 v21, v72, v74
    v_lshlrev_b32 v73, 16, v55
    v_and_b32 v74, 0xffff0000, v55
    v_fmac_f32 v22, v72, v73
    v_fmac_f32 v23, v72, v74
    ds_read_b32 v72, v7 offset:1536
    s_waitcnt vmcnt(3) lgkmcnt(0)
    v_lshlrev_b32 v73, 16, v56
    v_and_b32 v74, 0xffff0000, v56
    v_fmac_f32 v16, v72, v73
    v_fmac_f32 v17, v72, v74
    v_lshlrev_b32 v73, 16, v57
    v_and_b32 v74, 0xffff0000, v57
    v_fmac_f32 v18, v72, v73
    v_fmac_f32 v19, v72, v74
    v_lshlrev_b32 v73, 16, v58
    v_and_b32 v74, 0xffff0000, v58
    v_fmac_f32 v20, v72, v73
    v_fmac_f32 v21, v72, v74
    v_lshlrev_b32 v73, 16, v59
    v_and_b32 v74, 0xffff0000, v59
    v_fmac_f32 v22, v72, v73
    v_fmac_f32 v23, v72, v74
    ds_read_b32 v72, v7 offset:1792
    s_waitcnt vmcnt(2) lgkmcnt(0)
    v_lshlrev_b32 v73, 16, v60
    v_and_b32 v74, 0xffff0000, v60
    v_fmac_f32 v16, v72, v73
    v_fmac_f32 v17, v72, v74
    v_lshlrev_b32 v73, 16, v61
    v_and_b32 v74, 0xffff0000, v61
    v_fmac_f32 v18, v72, v73
    v_fmac_f32 v19, v72, v74
    v_lshlrev_b32 v73, 16, v62
    v_and_b32 v74, 0xffff0000, v62
    v_fmac_f32 v20, v72, v73
    v_fmac_f32 v21, v72, v74
    v_lshlrev_b32 v73, 16, v63
    v_and_b32 v74, 0xffff0000, v63
    v_fmac_f32 v22, v72, v73
    v_fmac_f32 v23, v72, v74
    ds_read_b32 v72, v7 offset:2048
    s_waitcnt vmcnt(1) lgkmcnt(0)
    v_lshlrev_b32 v73, 16, v64
    v_and_b32 v74, 0xffff0000, v64
    v_fmac_f32 v16, v72, v73
    v_fmac_f32 v17, v72, v74
    v_lshlrev_b32 v73, 16, v65
    v_and_b32 v74, 0xffff0000, v65
    v_fmac_f32 v18, v72, v73
    v_fmac_f32 v19, v72, v74
    v_lshlrev_b32 v73, 16, v66
    v_and_b32 v74, 0xffff0000, v66
    v_fmac_f32 v20, v72, v73
    v_fmac_f32 v21, v72, v74
    v_lshlrev_b32 v73, 16, v67
    v_and_b32 v74, 0xffff0000, v67
    v_fmac_f32 v22, v72, v73
    v_fmac_f32 v23, v72, v74
    ds_read_b32 v72, v7 offset:2304
    s_waitcnt vmcnt(0) lgkmcnt(0)
    v_lshlrev_b32 v73, 16, v68
    v_and_b32 v74, 0xffff0000, v68
    v_fmac_f32 v16, v72, v73
    v_fmac_f32 v17, v72, v74
    v_lshlrev_b32 v73, 16, v69
    v_and_b32 v74, 0xffff0000, v69
    v_fmac_f32 v18, v72, v73
    v_fmac_f32 v19, v72, v74
    v_lshlrev_b32 v73, 16, v70
    v_and_b32 v74, 0xffff0000, v70
    v_fmac_f32 v20, v72, v73
    v_fmac_f32 v21, v72, v74
    v_lshlrev_b32 v73, 16, v71
    v_and_b32 v74, 0xffff0000, v71
    v_fmac_f32 v22, v72, v73
    v_fmac_f32 v23, v72, v74
    v_lshlrev_b32 v72, 5, v0
    ds_write_b128 v72, v[16:19] offset:4096
    ds_write_b128 v72, v[20:23] offset:4112
    s_waitcnt lgkmcnt(0)
    s_barrier
    v_lshlrev_b32 v73, 2, v0
    v_mov_b32 v72, 0
    v_min_u32 v73, 124, v73
    ds_read_b32 v74, v73 offset:4096
    ds_read_b32 v75, v73 offset:4224
    ds_read_b32 v76, v73 offset:4352
    ds_read_b32 v77, v73 offset:4480
    ds_read_b32 v78, v73 offset:4608
    ds_read_b32 v79, v73 offset:4736
    ds_read_b32 v80, v73 offset:4864
    ds_read_b32 v81, v73 offset:4992
    s_waitcnt lgkmcnt(0)
    v_add_f32 v72, v72, v74
    v_add_f32 v72, v72, v75
    v_add_f32 v72, v72, v76
    v_add_f32 v72, v72, v77
    v_add_f32 v72, v72, v78
    v_add_f32 v72, v72, v79
    v_add_f32 v72, v72, v80
    v_add_f32 v72, v72, v81
    ds_read_b32 v74, v73 offset:5120
    ds_read_b32 v75, v73 offset:5248
    ds_read_b32 v76, v73 offset:5376
    ds_read_b32 v77, v73 offset:5504
    ds_read_b32 v78, v73 offset:5632
    ds_read_b32 v79, v73 offset:5760
    ds_read_b32 v80, v73 offset:5888
    ds_read_b32 v81, v73 offset:6016
    s_waitcnt lgkmcnt(0)
    v_add_f32 v72, v72, v74
    v_add_f32 v72, v72, v75
    v_add_f32 v72, v72, v76
    v_add_f32 v72, v72, v77
    v_add_f32 v72, v72, v78
    v_add_f32 v72, v72, v79
    v_add_f32 v72, v72, v80
    v_add_f32 v72, v72, v81
    ds_read_b32 v74, v73 offset:6144
    ds_read_b32 v75, v73 offset:6272
    ds_read_b32 v76, v73 offset:6400
    ds_read_b32 v77, v73 offset:6528
    ds_read_b32 v78, v73 offset:6656
    ds_read_b32 v79, v73 offset:6784
    ds_read_b32 v80, v73 offset:6912
    ds_read_b32 v81, v73 offset:7040
    s_waitcnt lgkmcnt(0)
    v_add_f32 v72, v72, v74
    v_add_f32 v72, v72, v75
    v_add_f32 v72, v72, v76
    v_add_f32 v72, v72, v77
    v_add_f32 v72, v72, v78
    v_add_f32 v72, v72, v79
    v_add_f32 v72, v72, v80
    v_add_f32 v72, v72, v81
    ds_read_b32 v74, v73 offset:7168
    ds_read_b32 v75, v73 offset:7296
    ds_read_b32 v76, v73 offset:7424
    ds_read_b32 v77, v73 offset:7552
    ds_read_b32 v78, v73 offset:7680
    ds_read_b32 v79, v73 offset:7808
    ds_read_b32 v80, v73 offset:7936
    ds_read_b32 v81, v73 offset:8064
    s_waitcnt lgkmcnt(0)
    v_add_f32 v72, v72, v74
    v_add_f32 v72, v72, v75
    v_add_f32 v72, v72, v76
    v_add_f32 v72, v72, v77
    v_add_f32 v72, v72, v78
    v_add_f32 v72, v72, v79
    v_add_f32 v72, v72, v80
    v_add_f32 v72, v72, v81
    ds_read_b32 v74, v73 offset:8192
    ds_read_b32 v75, v73 offset:8320
    ds_read_b32 v76, v73 offset:8448
    ds_read_b32 v77, v73 offset:8576
    ds_read_b32 v78, v73 offset:8704
    ds_read_b32 v79, v73 offset:8832
    ds_read_b32 v80, v73 offset:8960
    ds_read_b32 v81, v73 offset:9088
    s_waitcnt lgkmcnt(0)
    v_add_f32 v72, v72, v74
    v_add_f32 v72, v72, v75
    v_add_f32 v72, v72, v76
    v_add_f32 v72, v72, v77
    v_add_f32 v72, v72, v78
    v_add_f32 v72, v72, v79
    v_add_f32 v72, v72, v80
    v_add_f32 v72, v72, v81
    ds_read_b32 v74, v73 offset:9216
    ds_read_b32 v75, v73 offset:9344
    ds_read_b32 v76, v73 offset:9472
    ds_read_b32 v77, v73 offset:9600
    ds_read_b32 v78, v73 offset:9728
    ds_read_b32 v79, v73 offset:9856
    ds_read_b32 v80, v73 offset:9984
    ds_read_b32 v81, v73 offset:10112
    s_waitcnt lgkmcnt(0)
    v_add_f32 v72, v72, v74
    v_add_f32 v72, v72, v75
    v_add_f32 v72, v72, v76
    v_add_f32 v72, v72, v77
    v_add_f32 v72, v72, v78
    v_add_f32 v72, v72, v79
    v_add_f32 v72, v72, v80
    v_add_f32 v72, v72, v81
    ds_read_b32 v74, v73 offset:10240
    ds_read_b32 v75, v73 offset:10368
    ds_read_b32 v76, v73 offset:10496
    ds_read_b32 v77, v73 offset:10624
    ds_read_b32 v78, v73 offset:10752
    ds_read_b32 v79, v73 offset:10880
    ds_read_b32 v80, v73 offset:11008
    ds_read_b32 v81, v73 offset:11136
    s_waitcnt lgkmcnt(0)
    v_add_f32 v72, v72, v74
    v_add_f32 v72, v72, v75
    v_add_f32 v72, v72, v76
    v_add_f32 v72, v72, v77
    v_add_f32 v72, v72, v78
    v_add_f32 v72, v72, v79
    v_add_f32 v72, v72, v80
    v_add_f32 v72, v72, v81
    ds_read_b32 v74, v73 offset:11264
    ds_read_b32 v75, v73 offset:11392
    ds_read_b32 v76, v73 offset:11520
    ds_read_b32 v77, v73 offset:11648
    ds_read_b32 v78, v73 offset:11776
    ds_read_b32 v79, v73 offset:11904
    ds_read_b32 v80, v73 offset:12032
    ds_read_b32 v81, v73 offset:12160
    s_waitcnt lgkmcnt(0)
    v_add_f32 v72, v72, v74
    v_add_f32 v72, v72, v75
    v_add_f32 v72, v72, v76
    v_add_f32 v72, v72, v77
    v_add_f32 v72, v72, v78
    v_add_f32 v72, v72, v79
    v_add_f32 v72, v72, v80
    v_add_f32 v72, v72, v81
    v_cvt_pk_bf16_f32 v72, v72, v72
    s_lshl_b32 s23, s20, 6
    s_add_u32 s23, s23, s21
    v_lshlrev_b32 v1, 1, v0
    v_add_u32 v1, s23, v1
    v_cmp_gt_u32 vcc, 32, v0
    s_and_saveexec_b64 s[26:27], vcc
    buffer_store_short v72, v1, s[12:15], 0 offen
K1_END:
    s_endpgm
.p2align 8
.type qabs_kernel,@function
qabs_kernel:
    s_cmp_ge_u32 s2, 384
    s_cbranch_scc1 K2_END
    s_load_dwordx2 s[8:9], s[0:1], 64
    s_load_dwordx2 s[12:13], s[0:1], 104
    s_mov_b32 s10, 9437184
    s_mov_b32 s11, 0x00020000
    s_mov_b32 s14, 402653184
    s_mov_b32 s15, 0x00020000
    v_lshrrev_b32 v1, 6, v0
    s_nop 0
    v_readfirstlane_b32 s20, v1
    s_lshl_b32 s21, s2, 2
    s_add_u32 s20, s20, s21
    s_mov_b32 s21, 0x5555556
    s_mul_hi_u32 s22, s20, s21
    s_mul_i32 s23, s22, 48
    s_sub_u32 s23, s20, s23
    v_and_b32 v2, 63, v0
    v_and_b32 v3, 15, v2
    v_lshrrev_b32 v4, 4, v2
    v_lshlrev_b32 v5, 4, v4
    s_mul_i32 s24, s22, 384
    s_add_u32 s25, s24, 16384
    v_add_u32 v6, s25, v5
    s_lshl_b32 s26, s23, 4
    v_add_u32 v7, s26, v3
    s_mov_b32 s27, 12288
    v_mul_lo_u32 v7, v7, s27
    v_add_u32 v7, v7, v5
    v_add_u32 v7, s24, v7
    s_waitcnt lgkmcnt(0)
    buffer_load_dwordx4 v[16:19], v6, s[12:15], 0 offen offset:0
    buffer_load_dwordx4 v[20:23], v6, s[12:15], 0 offen offset:64
    buffer_load_dwordx4 v[24:27], v6, s[12:15], 0 offen offset:128
    buffer_load_dwordx4 v[28:31], v6, s[12:15], 0 offen offset:192
    buffer_load_dwordx4 v[32:35], v6, s[12:15], 0 offen offset:256
    buffer_load_dwordx4 v[36:39], v6, s[12:15], 0 offen offset:320
    buffer_load_dwordx4 v[40:43], v7, s[8:11], 0 offen offset:0
    buffer_load_dwordx4 v[44:47], v7, s[8:11], 0 offen offset:64
    buffer_load_dwordx4 v[48:51], v7, s[8:11], 0 offen offset:128
    buffer_load_dwordx4 v[52:55], v7, s[8:11], 0 offen offset:192
    buffer_load_dwordx4 v[56:59], v7, s[8:11], 0 offen offset:256
    buffer_load_dwordx4 v[60:63], v7, s[8:11], 0 offen offset:320
    v_mov_b32 v8, 0
    v_mov_b32 v9, 0
    v_mov_b32 v10, 0
    v_mov_b32 v11, 0
    s_waitcnt vmcnt(0)
    v_mfma_f32_16x16x32_bf16 v[8:11], v[40:43], v[16:19], v[8:11]
    v_mfma_f32_16x16x32_bf16 v[8:11], v[44:47], v[20:23], v[8:11]
    v_mfma_f32_16x16x32_bf16 v[8:11], v[48:51], v[24:27], v[8:11]
    v_mfma_f32_16x16x32_bf16 v[8:11], v[52:55], v[28:31], v[8:11]
    v_mfma_f32_16x16x32_bf16 v[8:11], v[56:59], v[32:35], v[8:11]
    v_mfma_f32_16x16x32_bf16 v[8:11], v[60:63], v[36:39], v[8:11]
    s_nop 15
    s_mov_b32 s27, 0x3dd53b95
    v_mul_f32 v8, s27, v8
    v_mul_f32 v9, s27, v9
    v_mul_f32 v10, s27, v10
    v_mul_f32 v11, s27, v11
    s_mul_i32 s24, s22, 3072
    s_lshl_b32 s26, s23, 6
    s_add_u32 s24, s24, s26
    s_add_u32 s24, s24, 32768
    v_add_u32 v6, s24, v5
    v_cmp_eq_u32 vcc, 0, v3
    s_and_saveexec_b64 s[26:27], vcc
    buffer_store_dwordx4 v[8:11], v6, s[12:15], 0 offen
K2_END:
    s_endpgm
.p2align 8
.type attn_kernel,@function
attn_kernel:
    s_cmp_ge_u32 s2, 288
    s_cbranch_scc1 K3_END
    s_load_dwordx2 s[12:13], s[0:1], 104
    s_mov_b32 s14, 402653184
    s_mov_b32 s15, 0x00020000
    v_and_b32 v2, 63, v0
    v_and_b32 v3, 15, v2
    v_lshrrev_b32 v4, 4, v2
    v_lshrrev_b32 v1, 6, v0
    s_nop 0
    v_readfirstlane_b32 s20, v1
    s_cmp_lt_u32 s2, 32
    s_cbranch_scc1 K3_B
    s_load_dwordx2 s[8:9], s[0:1], 8
    s_load_dwordx2 s[16:17], s[0:1], 16
    s_mov_b32 s10, 100663296
    s_mov_b32 s11, 0x00020000
    s_mov_b32 s18, 100663296
    s_mov_b32 s19, 0x00020000
    s_sub_u32 s21, s2, 32
    s_lshr_b32 s22, s21, 3
    s_and_b32 s23, s21, 7
    s_lshl_b32 s24, s23, 10
    s_lshl_b32 s25, s20, 4
    s_add_u32 s24, s24, s25
    s_mul_i32 s24, s24, 384
    s_mul_i32 s25, s22, 3145728
    s_add_u32 s24, s24, s25
    s_mov_b32 s26, 384
    v_mul_lo_u32 v10, v3, s26
    v_lshlrev_b32 v5, 4, v4
    v_add3_u32 v10, v10, v5, s24
    s_mov_b32 s27, 1536
    v_mul_lo_u32 v11, v4, s27
    v_add_u32 v11, s24, v11
    v_lshlrev_b32 v6, 3, v3
    v_add3_u32 v12, v11, v6, 0
    v_add_u32 v12, 256, v12
    v_lshlrev_b32 v6, 4, v3
    v_add_u32 v11, v11, v6
    s_mul_i32 s25, s22, 384
    s_add_u32 s25, s25, 0
    v_add_u32 v6, s25, v5
    s_waitcnt lgkmcnt(0)
    buffer_load_dwordx4 v[16:19], v6, s[12:15], 0 offen offset:0
    buffer_load_dwordx4 v[20:23], v6, s[12:15], 0 offen offset:64
    buffer_load_dwordx4 v[24:27], v6, s[12:15], 0 offen offset:128
    buffer_load_dwordx4 v[28:31], v6, s[12:15], 0 offen offset:192
    buffer_load_dwordx4 v[32:35], v6, s[12:15], 0 offen offset:256
    buffer_load_dwordx4 v[36:39], v6, s[12:15], 0 offen offset:320
    s_mov_b32 s30, 0
    buffer_load_dwordx4 v[64:67], v10, s[8:11], s30 offen offset:0 nt
    buffer_load_dwordx4 v[68:71], v10, s[8:11], s30 offen offset:64 nt
    buffer_load_dwordx4 v[72:75], v10, s[8:11], s30 offen offset:128 nt
    buffer_load_dwordx4 v[76:79], v10, s[8:11], s30 offen offset:192 nt
    buffer_load_dwordx4 v[80:83], v10, s[8:11], s30 offen offset:256 nt
    buffer_load_dwordx4 v[84:87], v10, s[8:11], s30 offen offset:320 nt
    buffer_load_dwordx4 v[88:91], v11, s[16:19], s30 offen offset:0 nt
    buffer_load_dwordx2 v[92:93], v12, s[16:19], s30 offen offset:0 nt
    buffer_load_dwordx4 v[94:97], v11, s[16:19], s30 offen offset:384 nt
    buffer_load_dwordx2 v[98:99], v12, s[16:19], s30 offen offset:384 nt
    buffer_load_dwordx4 v[100:103], v11, s[16:19], s30 offen offset:768 nt
    buffer_load_dwordx2 v[104:105], v12, s[16:19], s30 offen offset:768 nt
    buffer_load_dwordx4 v[106:109], v11, s[16:19], s30 offen offset:1152 nt
    buffer_load_dwordx2 v[110:111], v12, s[16:19], s30 offen offset:1152 nt
    s_mov_b32 s30, 24576
    buffer_load_dwordx4 v[112:115], v10, s[8:11], s30 offen offset:0 nt
    buffer_load_dwordx4 v[116:119], v10, s[8:11], s30 offen offset:64 nt
    buffer_load_dwordx4 v[120:123], v10, s[8:11], s30 offen offset:128 nt
    buffer_load_dwordx4 v[124:127], v10, s[8:11], s30 offen offset:192 nt
    buffer_load_dwordx4 v[128:131], v10, s[8:11], s30 offen offset:256 nt
    buffer_load_dwordx4 v[132:135], v10, s[8:11], s30 offen offset:320 nt
    buffer_load_dwordx4 v[136:139], v11, s[16:19], s30 offen offset:0 nt
    buffer_load_dwordx2 v[140:141], v12, s[16:19], s30 offen offset:0 nt
    buffer_load_dwordx4 v[142:145], v11, s[16:19], s30 offen offset:384 nt
    buffer_load_dwordx2 v[146:147], v12, s[16:19], s30 offen offset:384 nt
    buffer_load_dwordx4 v[148:151], v11, s[16:19], s30 offen offset:768 nt
    buffer_load_dwordx2 v[152:153], v12, s[16:19], s30 offen offset:768 nt
    buffer_load_dwordx4 v[154:157], v11, s[16:19], s30 offen offset:1152 nt
    buffer_load_dwordx2 v[158:159], v12, s[16:19], s30 offen offset:1152 nt
    v_mov_b32 v44, 0xf149f2ca
    v_mov_b32 v45, 0
    v_mov_b32 v48, 0
    v_mov_b32 v49, 0
    v_mov_b32 v50, 0
    v_mov_b32 v51, 0
    v_mov_b32 v52, 0
    v_mov_b32 v53, 0
    v_mov_b32 v54, 0
    v_mov_b32 v55, 0
    v_mov_b32 v56, 0
    v_mov_b32 v57, 0
    v_mov_b32 v58, 0
    v_mov_b32 v59, 0
    s_mov_b32 s31, 0x3dd53b95
    s_mov_b32 s30, 49152
    buffer_load_dwordx4 v[160:163], v10, s[8:11], s30 offen offset:0 nt
    buffer_load_dwordx4 v[164:167], v10, s[8:11], s30 offen offset:64 nt
    buffer_load_dwordx4 v[168:171], v10, s[8:11], s30 offen offset:128 nt
    buffer_load_dwordx4 v[172:175], v10, s[8:11], s30 offen offset:192 nt
    buffer_load_dwordx4 v[176:179], v10, s[8:11], s30 offen offset:256 nt
    buffer_load_dwordx4 v[180:183], v10, s[8:11], s30 offen offset:320 nt
    buffer_load_dwordx4 v[184:187], v11, s[16:19], s30 offen offset:0 nt
    buffer_load_dwordx2 v[188:189], v12, s[16:19], s30 offen offset:0 nt
    buffer_load_dwordx4 v[190:193], v11, s[16:19], s30 offen offset:384 nt
    buffer_load_dwordx2 v[194:195], v12, s[16:19], s30 offen offset:384 nt
    buffer_load_dwordx4 v[196:199], v11, s[16:19], s30 offen offset:768 nt
    buffer_load_dwordx2 v[200:201], v12, s[16:19], s30 offen offset:768 nt
    buffer_load_dwordx4 v[202:205], v11, s[16:19], s30 offen offset:1152 nt
    buffer_load_dwordx2 v[206:207], v12, s[16:19], s30 offen offset:1152 nt
    s_waitcnt vmcnt(28)
    v_mov_b32 v40, 0
    v_mov_b32 v41, 0
    v_mov_b32 v42, 0
    v_mov_b32 v43, 0
    s_nop 1
    v_mfma_f32_16x16x32_bf16 v[40:43], v[64:67], v[16:19], v[40:43]
    v_mfma_f32_16x16x32_bf16 v[40:43], v[68:71], v[20:23], v[40:43]
    v_mfma_f32_16x16x32_bf16 v[40:43], v[72:75], v[24:27], v[40:43]
    v_mfma_f32_16x16x32_bf16 v[40:43], v[76:79], v[28:31], v[40:43]
    v_mfma_f32_16x16x32_bf16 v[40:43], v[80:83], v[32:35], v[40:43]
    v_mfma_f32_16x16x32_bf16 v[40:43], v[84:87], v[36:39], v[40:43]
    s_nop 9
    v_mul_f32 v40, s31, v40
    v_mul_f32 v41, s31, v41
    v_mul_f32 v42, s31, v42
    v_mul_f32 v43, s31, v43
    v_max3_f32 v46, v40, v41, v42
    v_max_f32 v46, v46, v43
    v_mov_b32 v60, v46
    v_mov_b32 v61, v46
    s_nop 1
    v_permlane32_swap_b32 v60, v61
    s_nop 1
    v_max_f32 v46, v60, v61
    v_mov_b32 v60, v46
    v_mov_b32 v61, v46
    s_nop 1
    v_permlane16_swap_b32 v60, v61
    s_nop 1
    v_max_f32 v46, v60, v61
    v_max_f32 v46, v46, v44
    v_sub_f32 v47, v44, v46
    v_exp_f32 v47, v47
    v_mov_b32 v44, v46
    v_sub_f32 v40, v40, v46
    v_sub_f32 v41, v41, v46
    v_sub_f32 v42, v42, v46
    v_sub_f32 v43, v43, v46
    v_exp_f32 v40, v40
    v_exp_f32 v41, v41
    v_exp_f32 v42, v42
    v_exp_f32 v43, v43
    v_mul_f32 v45, v45, v47
    v_mul_f32 v48, v48, v47
    v_mul_f32 v49, v49, v47
    v_mul_f32 v50, v50, v47
    v_mul_f32 v51, v51, v47
    v_mul_f32 v52, v52, v47
    v_mul_f32 v53, v53, v47
    v_mul_f32 v54, v54, v47
    v_mul_f32 v55, v55, v47
    v_mul_f32 v56, v56, v47
    v_mul_f32 v57, v57, v47
    v_mul_f32 v58, v58, v47
    v_mul_f32 v59, v59, v47
    v_add_f32 v45, v45, v40
    v_add_f32 v45, v45, v41
    v_add_f32 v45, v45, v42
    v_add_f32 v45, v45, v43
    v_lshlrev_b32 v60, 16, v88
    v_and_b32 v61, 0xffff0000, v88
    v_fmac_f32 v48, v40, v60
    v_fmac_f32 v49, v40, v61
    v_lshlrev_b32 v60, 16, v89
    v_and_b32 v61, 0xffff0000, v89
    v_fmac_f32 v50, v40, v60
    v_fmac_f32 v51, v40, v61
    v_lshlrev_b32 v60, 16, v90
    v_and_b32 v61, 0xffff0000, v90
    v_fmac_f32 v52, v40, v60
    v_fmac_f32 v53, v40, v61
    v_lshlrev_b32 v60, 16, v91
    v_and_b32 v61, 0xffff0000, v91
    v_fmac_f32 v54, v40, v60
    v_fmac_f32 v55, v40, v61
    v_lshlrev_b32 v60, 16, v92
    v_and_b32 v61, 0xffff0000, v92
    v_fmac_f32 v56, v40, v60
    v_fmac_f32 v57, v40, v61
    v_lshlrev_b32 v60, 16, v93
    v_and_b32 v61, 0xffff0000, v93
    v_fmac_f32 v58, v40, v60
    v_fmac_f32 v59, v40, v61
    v_lshlrev_b32 v60, 16, v94
    v_and_b32 v61, 0xffff0000, v94
    v_fmac_f32 v48, v41, v60
    v_fmac_f32 v49, v41, v61
    v_lshlrev_b32 v60, 16, v95
    v_and_b32 v61, 0xffff0000, v95
    v_fmac_f32 v50, v41, v60
    v_fmac_f32 v51, v41, v61
    v_lshlrev_b32 v60, 16, v96
    v_and_b32 v61, 0xffff0000, v96
    v_fmac_f32 v52, v41, v60
    v_fmac_f32 v53, v41, v61
    v_lshlrev_b32 v60, 16, v97
    v_and_b32 v61, 0xffff0000, v97
    v_fmac_f32 v54, v41, v60
    v_fmac_f32 v55, v41, v61
    v_lshlrev_b32 v60, 16, v98
    v_and_b32 v61, 0xffff0000, v98
    v_fmac_f32 v56, v41, v60
    v_fmac_f32 v57, v41, v61
    v_lshlrev_b32 v60, 16, v99
    v_and_b32 v61, 0xffff0000, v99
    v_fmac_f32 v58, v41, v60
    v_fmac_f32 v59, v41, v61
    v_lshlrev_b32 v60, 16, v100
    v_and_b32 v61, 0xffff0000, v100
    v_fmac_f32 v48, v42, v60
    v_fmac_f32 v49, v42, v61
    v_lshlrev_b32 v60, 16, v101
    v_and_b32 v61, 0xffff0000, v101
    v_fmac_f32 v50, v42, v60
    v_fmac_f32 v51, v42, v61
    v_lshlrev_b32 v60, 16, v102
    v_and_b32 v61, 0xffff0000, v102
    v_fmac_f32 v52, v42, v60
    v_fmac_f32 v53, v42, v61
    v_lshlrev_b32 v60, 16, v103
    v_and_b32 v61, 0xffff0000, v103
    v_fmac_f32 v54, v42, v60
    v_fmac_f32 v55, v42, v61
    v_lshlrev_b32 v60, 16, v104
    v_and_b32 v61, 0xffff0000, v104
    v_fmac_f32 v56, v42, v60
    v_fmac_f32 v57, v42, v61
    v_lshlrev_b32 v60, 16, v105
    v_and_b32 v61, 0xffff0000, v105
    v_fmac_f32 v58, v42, v60
    v_fmac_f32 v59, v42, v61
    v_lshlrev_b32 v60, 16, v106
    v_and_b32 v61, 0xffff0000, v106
    v_fmac_f32 v48, v43, v60
    v_fmac_f32 v49, v43, v61
    v_lshlrev_b32 v60, 16, v107
    v_and_b32 v61, 0xffff0000, v107
    v_fmac_f32 v50, v43, v60
    v_fmac_f32 v51, v43, v61
    v_lshlrev_b32 v60, 16, v108
    v_and_b32 v61, 0xffff0000, v108
    v_fmac_f32 v52, v43, v60
    v_fmac_f32 v53, v43, v61
    v_lshlrev_b32 v60, 16, v109
    v_and_b32 v61, 0xffff0000, v109
    v_fmac_f32 v54, v43, v60
    v_fmac_f32 v55, v43, v61
    v_lshlrev_b32 v60, 16, v110
    v_and_b32 v61, 0xffff0000, v110
    v_fmac_f32 v56, v43, v60
    v_fmac_f32 v57, v43, v61
    v_lshlrev_b32 v60, 16, v111
    v_and_b32 v61, 0xffff0000, v111
    v_fmac_f32 v58, v43, v60
    v_fmac_f32 v59, v43, v61
    s_mov_b32 s30, 73728
    buffer_load_dwordx4 v[64:67], v10, s[8:11], s30 offen offset:0 nt
    buffer_load_dwordx4 v[68:71], v10, s[8:11], s30 offen offset:64 nt
    buffer_load_dwordx4 v[72:75], v10, s[8:11], s30 offen offset:128 nt
    buffer_load_dwordx4 v[76:79], v10, s[8:11], s30 offen offset:192 nt
    buffer_load_dwordx4 v[80:83], v10, s[8:11], s30 offen offset:256 nt
    buffer_load_dwordx4 v[84:87], v10, s[8:11], s30 offen offset:320 nt
    buffer_load_dwordx4 v[88:91], v11, s[16:19], s30 offen offset:0 nt
    buffer_load_dwordx2 v[92:93], v12, s[16:19], s30 offen offset:0 nt
    buffer_load_dwordx4 v[94:97], v11, s[16:19], s30 offen offset:384 nt
    buffer_load_dwordx2 v[98:99], v12, s[16:19], s30 offen offset:384 nt
    buffer_load_dwordx4 v[100:103], v11, s[16:19], s30 offen offset:768 nt
    buffer_load_dwordx2 v[104:105], v12, s[16:19], s30 offen offset:768 nt
    buffer_load_dwordx4 v[106:109], v11, s[16:19], s30 offen offset:1152 nt
    buffer_load_dwordx2 v[110:111], v12, s[16:19], s30 offen offset:1152 nt
    s_waitcnt vmcnt(28)
    v_mov_b32 v40, 0
    v_mov_b32 v41, 0
    v_mov_b32 v42, 0
    v_mov_b32 v43, 0
    s_nop 1
    v_mfma_f32_16x16x32_bf16 v[40:43], v[112:115], v[16:19], v[40:43]
    v_mfma_f32_16x16x32_bf16 v[40:43], v[116:119], v[20:23], v[40:43]
    v_mfma_f32_16x16x32_bf16 v[40:43], v[120:123], v[24:27], v[40:43]
    v_mfma_f32_16x16x32_bf16 v[40:43], v[124:127], v[28:31], v[40:43]
    v_mfma_f32_16x16x32_bf16 v[40:43], v[128:131], v[32:35], v[40:43]
    v_mfma_f32_16x16x32_bf16 v[40:43], v[132:135], v[36:39], v[40:43]
    s_nop 9
    v_mul_f32 v40, s31, v40
    v_mul_f32 v41, s31, v41
    v_mul_f32 v42, s31, v42
    v_mul_f32 v43, s31, v43
    v_max3_f32 v46, v40, v41, v42
    v_max_f32 v46, v46, v43
    v_mov_b32 v60, v46
    v_mov_b32 v61, v46
    s_nop 1
    v_permlane32_swap_b32 v60, v61
    s_nop 1
    v_max_f32 v46, v60, v61
    v_mov_b32 v60, v46
    v_mov_b32 v61, v46
    s_nop 1
    v_permlane16_swap_b32 v60, v61
    s_nop 1
    v_max_f32 v46, v60, v61
    v_max_f32 v46, v46, v44
    v_sub_f32 v47, v44, v46
    v_exp_f32 v47, v47
    v_mov_b32 v44, v46
    v_sub_f32 v40, v40, v46
    v_sub_f32 v41, v41, v46
    v_sub_f32 v42, v42, v46
    v_sub_f32 v43, v43, v46
    v_exp_f32 v40, v40
    v_exp_f32 v41, v41
    v_exp_f32 v42, v42
    v_exp_f32 v43, v43
    v_mul_f32 v45, v45, v47
    v_mul_f32 v48, v48, v47
    v_mul_f32 v49, v49, v47
    v_mul_f32 v50, v50, v47
    v_mul_f32 v51, v51, v47
    v_mul_f32 v52, v52, v47
    v_mul_f32 v53, v53, v47
    v_mul_f32 v54, v54, v47
    v_mul_f32 v55, v55, v47
    v_mul_f32 v56, v56, v47
    v_mul_f32 v57, v57, v47
    v_mul_f32 v58, v58, v47
    v_mul_f32 v59, v59, v47
    v_add_f32 v45, v45, v40
    v_add_f32 v45, v45, v41
    v_add_f32 v45, v45, v42
    v_add_f32 v45, v45, v43
    v_lshlrev_b32 v60, 16, v136
    v_and_b32 v61, 0xffff0000, v136
    v_fmac_f32 v48, v40, v60
    v_fmac_f32 v49, v40, v61
    v_lshlrev_b32 v60, 16, v137
    v_and_b32 v61, 0xffff0000, v137
    v_fmac_f32 v50, v40, v60
    v_fmac_f32 v51, v40, v61
    v_lshlrev_b32 v60, 16, v138
    v_and_b32 v61, 0xffff0000, v138
    v_fmac_f32 v52, v40, v60
    v_fmac_f32 v53, v40, v61
    v_lshlrev_b32 v60, 16, v139
    v_and_b32 v61, 0xffff0000, v139
    v_fmac_f32 v54, v40, v60
    v_fmac_f32 v55, v40, v61
    v_lshlrev_b32 v60, 16, v140
    v_and_b32 v61, 0xffff0000, v140
    v_fmac_f32 v56, v40, v60
    v_fmac_f32 v57, v40, v61
    v_lshlrev_b32 v60, 16, v141
    v_and_b32 v61, 0xffff0000, v141
    v_fmac_f32 v58, v40, v60
    v_fmac_f32 v59, v40, v61
    v_lshlrev_b32 v60, 16, v142
    v_and_b32 v61, 0xffff0000, v142
    v_fmac_f32 v48, v41, v60
    v_fmac_f32 v49, v41, v61
    v_lshlrev_b32 v60, 16, v143
    v_and_b32 v61, 0xffff0000, v143
    v_fmac_f32 v50, v41, v60
    v_fmac_f32 v51, v41, v61
    v_lshlrev_b32 v60, 16, v144
    v_and_b32 v61, 0xffff0000, v144
    v_fmac_f32 v52, v41, v60
    v_fmac_f32 v53, v41, v61
    v_lshlrev_b32 v60, 16, v145
    v_and_b32 v61, 0xffff0000, v145
    v_fmac_f32 v54, v41, v60
    v_fmac_f32 v55, v41, v61
    v_lshlrev_b32 v60, 16, v146
    v_and_b32 v61, 0xffff0000, v146
    v_fmac_f32 v56, v41, v60
    v_fmac_f32 v57, v41, v61
    v_lshlrev_b32 v60, 16, v147
    v_and_b32 v61, 0xffff0000, v147
    v_fmac_f32 v58, v41, v60
    v_fmac_f32 v59, v41, v61
    v_lshlrev_b32 v60, 16, v148
    v_and_b32 v61, 0xffff0000, v148
    v_fmac_f32 v48, v42, v60
    v_fmac_f32 v49, v42, v61
    v_lshlrev_b32 v60, 16, v149
    v_and_b32 v61, 0xffff0000, v149
    v_fmac_f32 v50, v42, v60
    v_fmac_f32 v51, v42, v61
    v_lshlrev_b32 v60, 16, v150
    v_and_b32 v61, 0xffff0000, v150
    v_fmac_f32 v52, v42, v60
    v_fmac_f32 v53, v42, v61
    v_lshlrev_b32 v60, 16, v151
    v_and_b32 v61, 0xffff0000, v151
    v_fmac_f32 v54, v42, v60
    v_fmac_f32 v55, v42, v61
    v_lshlrev_b32 v60, 16, v152
    v_and_b32 v61, 0xffff0000, v152
    v_fmac_f32 v56, v42, v60
    v_fmac_f32 v57, v42, v61
    v_lshlrev_b32 v60, 16, v153
    v_and_b32 v61, 0xffff0000, v153
    v_fmac_f32 v58, v42, v60
    v_fmac_f32 v59, v42, v61
    v_lshlrev_b32 v60, 16, v154
    v_and_b32 v61, 0xffff0000, v154
    v_fmac_f32 v48, v43, v60
    v_fmac_f32 v49, v43, v61
    v_lshlrev_b32 v60, 16, v155
    v_and_b32 v61, 0xffff0000, v155
    v_fmac_f32 v50, v43, v60
    v_fmac_f32 v51, v43, v61
    v_lshlrev_b32 v60, 16, v156
    v_and_b32 v61, 0xffff0000, v156
    v_fmac_f32 v52, v43, v60
    v_fmac_f32 v53, v43, v61
    v_lshlrev_b32 v60, 16, v157
    v_and_b32 v61, 0xffff0000, v157
    v_fmac_f32 v54, v43, v60
    v_fmac_f32 v55, v43, v61
    v_lshlrev_b32 v60, 16, v158
    v_and_b32 v61, 0xffff0000, v158
    v_fmac_f32 v56, v43, v60
    v_fmac_f32 v57, v43, v61
    v_lshlrev_b32 v60, 16, v159
    v_and_b32 v61, 0xffff0000, v159
    v_fmac_f32 v58, v43, v60
    v_fmac_f32 v59, v43, v61
    s_mov_b32 s30, 98304
    buffer_load_dwordx4 v[112:115], v10, s[8:11], s30 offen offset:0 nt
    buffer_load_dwordx4 v[116:119], v10, s[8:11], s30 offen offset:64 nt
    buffer_load_dwordx4 v[120:123], v10, s[8:11], s30 offen offset:128 nt
    buffer_load_dwordx4 v[124:127], v10, s[8:11], s30 offen offset:192 nt
    buffer_load_dwordx4 v[128:131], v10, s[8:11], s30 offen offset:256 nt
    buffer_load_dwordx4 v[132:135], v10, s[8:11], s30 offen offset:320 nt
    buffer_load_dwordx4 v[136:139], v11, s[16:19], s30 offen offset:0 nt
    buffer_load_dwordx2 v[140:141], v12, s[16:19], s30 offen offset:0 nt
    buffer_load_dwordx4 v[142:145], v11, s[16:19], s30 offen offset:384 nt
    buffer_load_dwordx2 v[146:147], v12, s[16:19], s30 offen offset:384 nt
    buffer_load_dwordx4 v[148:151], v11, s[16:19], s30 offen offset:768 nt
    buffer_load_dwordx2 v[152:153], v12, s[16:19], s30 offen offset:768 nt
    buffer_load_dwordx4 v[154:157], v11, s[16:19], s30 offen offset:1152 nt
    buffer_load_dwordx2 v[158:159], v12, s[16:19], s30 offen offset:1152 nt
    s_waitcnt vmcnt(28)
    v_mov_b32 v40, 0
    v_mov_b32 v41, 0
    v_mov_b32 v42, 0
    v_mov_b32 v43, 0
    s_nop 1
    v_mfma_f32_16x16x32_bf16 v[40:43], v[160:163], v[16:19], v[40:43]
    v_mfma_f32_16x16x32_bf16 v[40:43], v[164:167], v[20:23], v[40:43]
    v_mfma_f32_16x16x32_bf16 v[40:43], v[168:171], v[24:27], v[40:43]
    v_mfma_f32_16x16x32_bf16 v[40:43], v[172:175], v[28:31], v[40:43]
    v_mfma_f32_16x16x32_bf16 v[40:43], v[176:179], v[32:35], v[40:43]
    v_mfma_f32_16x16x32_bf16 v[40:43], v[180:183], v[36:39], v[40:43]
    s_nop 9
    v_mul_f32 v40, s31, v40
    v_mul_f32 v41, s31, v41
    v_mul_f32 v42, s31, v42
    v_mul_f32 v43, s31, v43
    v_max3_f32 v46, v40, v41, v42
    v_max_f32 v46, v46, v43
    v_mov_b32 v60, v46
    v_mov_b32 v61, v46
    s_nop 1
    v_permlane32_swap_b32 v60, v61
    s_nop 1
    v_max_f32 v46, v60, v61
    v_mov_b32 v60, v46
    v_mov_b32 v61, v46
    s_nop 1
    v_permlane16_swap_b32 v60, v61
    s_nop 1
    v_max_f32 v46, v60, v61
    v_max_f32 v46, v46, v44
    v_sub_f32 v47, v44, v46
    v_exp_f32 v47, v47
    v_mov_b32 v44, v46
    v_sub_f32 v40, v40, v46
    v_sub_f32 v41, v41, v46
    v_sub_f32 v42, v42, v46
    v_sub_f32 v43, v43, v46
    v_exp_f32 v40, v40
    v_exp_f32 v41, v41
    v_exp_f32 v42, v42
    v_exp_f32 v43, v43
    v_mul_f32 v45, v45, v47
    v_mul_f32 v48, v48, v47
    v_mul_f32 v49, v49, v47
    v_mul_f32 v50, v50, v47
    v_mul_f32 v51, v51, v47
    v_mul_f32 v52, v52, v47
    v_mul_f32 v53, v53, v47
    v_mul_f32 v54, v54, v47
    v_mul_f32 v55, v55, v47
    v_mul_f32 v56, v56, v47
    v_mul_f32 v57, v57, v47
    v_mul_f32 v58, v58, v47
    v_mul_f32 v59, v59, v47
    v_add_f32 v45, v45, v40
    v_add_f32 v45, v45, v41
    v_add_f32 v45, v45, v42
    v_add_f32 v45, v45, v43
    v_lshlrev_b32 v60, 16, v184
    v_and_b32 v61, 0xffff0000, v184
    v_fmac_f32 v48, v40, v60
    v_fmac_f32 v49, v40, v61
    v_lshlrev_b32 v60, 16, v185
    v_and_b32 v61, 0xffff0000, v185
    v_fmac_f32 v50, v40, v60
    v_fmac_f32 v51, v40, v61
    v_lshlrev_b32 v60, 16, v186
    v_and_b32 v61, 0xffff0000, v186
    v_fmac_f32 v52, v40, v60
    v_fmac_f32 v53, v40, v61
    v_lshlrev_b32 v60, 16, v187
    v_and_b32 v61, 0xffff0000, v187
    v_fmac_f32 v54, v40, v60
    v_fmac_f32 v55, v40, v61
    v_lshlrev_b32 v60, 16, v188
    v_and_b32 v61, 0xffff0000, v188
    v_fmac_f32 v56, v40, v60
    v_fmac_f32 v57, v40, v61
    v_lshlrev_b32 v60, 16, v189
    v_and_b32 v61, 0xffff0000, v189
    v_fmac_f32 v58, v40, v60
    v_fmac_f32 v59, v40, v61
    v_lshlrev_b32 v60, 16, v190
    v_and_b32 v61, 0xffff0000, v190
    v_fmac_f32 v48, v41, v60
    v_fmac_f32 v49, v41, v61
    v_lshlrev_b32 v60, 16, v191
    v_and_b32 v61, 0xffff0000, v191
    v_fmac_f32 v50, v41, v60
    v_fmac_f32 v51, v41, v61
    v_lshlrev_b32 v60, 16, v192
    v_and_b32 v61, 0xffff0000, v192
    v_fmac_f32 v52, v41, v60
    v_fmac_f32 v53, v41, v61
    v_lshlrev_b32 v60, 16, v193
    v_and_b32 v61, 0xffff0000, v193
    v_fmac_f32 v54, v41, v60
    v_fmac_f32 v55, v41, v61
    v_lshlrev_b32 v60, 16, v194
    v_and_b32 v61, 0xffff0000, v194
    v_fmac_f32 v56, v41, v60
    v_fmac_f32 v57, v41, v61
    v_lshlrev_b32 v60, 16, v195
    v_and_b32 v61, 0xffff0000, v195
    v_fmac_f32 v58, v41, v60
    v_fmac_f32 v59, v41, v61
    v_lshlrev_b32 v60, 16, v196
    v_and_b32 v61, 0xffff0000, v196
    v_fmac_f32 v48, v42, v60
    v_fmac_f32 v49, v42, v61
    v_lshlrev_b32 v60, 16, v197
    v_and_b32 v61, 0xffff0000, v197
    v_fmac_f32 v50, v42, v60
    v_fmac_f32 v51, v42, v61
    v_lshlrev_b32 v60, 16, v198
    v_and_b32 v61, 0xffff0000, v198
    v_fmac_f32 v52, v42, v60
    v_fmac_f32 v53, v42, v61
    v_lshlrev_b32 v60, 16, v199
    v_and_b32 v61, 0xffff0000, v199
    v_fmac_f32 v54, v42, v60
    v_fmac_f32 v55, v42, v61
    v_lshlrev_b32 v60, 16, v200
    v_and_b32 v61, 0xffff0000, v200
    v_fmac_f32 v56, v42, v60
    v_fmac_f32 v57, v42, v61
    v_lshlrev_b32 v60, 16, v201
    v_and_b32 v61, 0xffff0000, v201
    v_fmac_f32 v58, v42, v60
    v_fmac_f32 v59, v42, v61
    v_lshlrev_b32 v60, 16, v202
    v_and_b32 v61, 0xffff0000, v202
    v_fmac_f32 v48, v43, v60
    v_fmac_f32 v49, v43, v61
    v_lshlrev_b32 v60, 16, v203
    v_and_b32 v61, 0xffff0000, v203
    v_fmac_f32 v50, v43, v60
    v_fmac_f32 v51, v43, v61
    v_lshlrev_b32 v60, 16, v204
    v_and_b32 v61, 0xffff0000, v204
    v_fmac_f32 v52, v43, v60
    v_fmac_f32 v53, v43, v61
    v_lshlrev_b32 v60, 16, v205
    v_and_b32 v61, 0xffff0000, v205
    v_fmac_f32 v54, v43, v60
    v_fmac_f32 v55, v43, v61
    v_lshlrev_b32 v60, 16, v206
    v_and_b32 v61, 0xffff0000, v206
    v_fmac_f32 v56, v43, v60
    v_fmac_f32 v57, v43, v61
    v_lshlrev_b32 v60, 16, v207
    v_and_b32 v61, 0xffff0000, v207
    v_fmac_f32 v58, v43, v60
    v_fmac_f32 v59, v43, v61
    s_mov_b32 s30, 122880
    buffer_load_dwordx4 v[160:163], v10, s[8:11], s30 offen offset:0 nt
    buffer_load_dwordx4 v[164:167], v10, s[8:11], s30 offen offset:64 nt
    buffer_load_dwordx4 v[168:171], v10, s[8:11], s30 offen offset:128 nt
    buffer_load_dwordx4 v[172:175], v10, s[8:11], s30 offen offset:192 nt
    buffer_load_dwordx4 v[176:179], v10, s[8:11], s30 offen offset:256 nt
    buffer_load_dwordx4 v[180:183], v10, s[8:11], s30 offen offset:320 nt
    buffer_load_dwordx4 v[184:187], v11, s[16:19], s30 offen offset:0 nt
    buffer_load_dwordx2 v[188:189], v12, s[16:19], s30 offen offset:0 nt
    buffer_load_dwordx4 v[190:193], v11, s[16:19], s30 offen offset:384 nt
    buffer_load_dwordx2 v[194:195], v12, s[16:19], s30 offen offset:384 nt
    buffer_load_dwordx4 v[196:199], v11, s[16:19], s30 offen offset:768 nt
    buffer_load_dwordx2 v[200:201], v12, s[16:19], s30 offen offset:768 nt
    buffer_load_dwordx4 v[202:205], v11, s[16:19], s30 offen offset:1152 nt
    buffer_load_dwordx2 v[206:207], v12, s[16:19], s30 offen offset:1152 nt
    s_waitcnt vmcnt(28)
    v_mov_b32 v40, 0
    v_mov_b32 v41, 0
    v_mov_b32 v42, 0
    v_mov_b32 v43, 0
    s_nop 1
    v_mfma_f32_16x16x32_bf16 v[40:43], v[64:67], v[16:19], v[40:43]
    v_mfma_f32_16x16x32_bf16 v[40:43], v[68:71], v[20:23], v[40:43]
    v_mfma_f32_16x16x32_bf16 v[40:43], v[72:75], v[24:27], v[40:43]
    v_mfma_f32_16x16x32_bf16 v[40:43], v[76:79], v[28:31], v[40:43]
    v_mfma_f32_16x16x32_bf16 v[40:43], v[80:83], v[32:35], v[40:43]
    v_mfma_f32_16x16x32_bf16 v[40:43], v[84:87], v[36:39], v[40:43]
    s_nop 9
    v_mul_f32 v40, s31, v40
    v_mul_f32 v41, s31, v41
    v_mul_f32 v42, s31, v42
    v_mul_f32 v43, s31, v43
    v_max3_f32 v46, v40, v41, v42
    v_max_f32 v46, v46, v43
    v_mov_b32 v60, v46
    v_mov_b32 v61, v46
    s_nop 1
    v_permlane32_swap_b32 v60, v61
    s_nop 1
    v_max_f32 v46, v60, v61
    v_mov_b32 v60, v46
    v_mov_b32 v61, v46
    s_nop 1
    v_permlane16_swap_b32 v60, v61
    s_nop 1
    v_max_f32 v46, v60, v61
    v_max_f32 v46, v46, v44
    v_sub_f32 v47, v44, v46
    v_exp_f32 v47, v47
    v_mov_b32 v44, v46
    v_sub_f32 v40, v40, v46
    v_sub_f32 v41, v41, v46
    v_sub_f32 v42, v42, v46
    v_sub_f32 v43, v43, v46
    v_exp_f32 v40, v40
    v_exp_f32 v41, v41
    v_exp_f32 v42, v42
    v_exp_f32 v43, v43
    v_mul_f32 v45, v45, v47
    v_mul_f32 v48, v48, v47
    v_mul_f32 v49, v49, v47
    v_mul_f32 v50, v50, v47
    v_mul_f32 v51, v51, v47
    v_mul_f32 v52, v52, v47
    v_mul_f32 v53, v53, v47
    v_mul_f32 v54, v54, v47
    v_mul_f32 v55, v55, v47
    v_mul_f32 v56, v56, v47
    v_mul_f32 v57, v57, v47
    v_mul_f32 v58, v58, v47
    v_mul_f32 v59, v59, v47
    v_add_f32 v45, v45, v40
    v_add_f32 v45, v45, v41
    v_add_f32 v45, v45, v42
    v_add_f32 v45, v45, v43
    v_lshlrev_b32 v60, 16, v88
    v_and_b32 v61, 0xffff0000, v88
    v_fmac_f32 v48, v40, v60
    v_fmac_f32 v49, v40, v61
    v_lshlrev_b32 v60, 16, v89
    v_and_b32 v61, 0xffff0000, v89
    v_fmac_f32 v50, v40, v60
    v_fmac_f32 v51, v40, v61
    v_lshlrev_b32 v60, 16, v90
    v_and_b32 v61, 0xffff0000, v90
    v_fmac_f32 v52, v40, v60
    v_fmac_f32 v53, v40, v61
    v_lshlrev_b32 v60, 16, v91
    v_and_b32 v61, 0xffff0000, v91
    v_fmac_f32 v54, v40, v60
    v_fmac_f32 v55, v40, v61
    v_lshlrev_b32 v60, 16, v92
    v_and_b32 v61, 0xffff0000, v92
    v_fmac_f32 v56, v40, v60
    v_fmac_f32 v57, v40, v61
    v_lshlrev_b32 v60, 16, v93
    v_and_b32 v61, 0xffff0000, v93
    v_fmac_f32 v58, v40, v60
    v_fmac_f32 v59, v40, v61
    v_lshlrev_b32 v60, 16, v94
    v_and_b32 v61, 0xffff0000, v94
    v_fmac_f32 v48, v41, v60
    v_fmac_f32 v49, v41, v61
    v_lshlrev_b32 v60, 16, v95
    v_and_b32 v61, 0xffff0000, v95
    v_fmac_f32 v50, v41, v60
    v_fmac_f32 v51, v41, v61
    v_lshlrev_b32 v60, 16, v96
    v_and_b32 v61, 0xffff0000, v96
    v_fmac_f32 v52, v41, v60
    v_fmac_f32 v53, v41, v61
    v_lshlrev_b32 v60, 16, v97
    v_and_b32 v61, 0xffff0000, v97
    v_fmac_f32 v54, v41, v60
    v_fmac_f32 v55, v41, v61
    v_lshlrev_b32 v60, 16, v98
    v_and_b32 v61, 0xffff0000, v98
    v_fmac_f32 v56, v41, v60
    v_fmac_f32 v57, v41, v61
    v_lshlrev_b32 v60, 16, v99
    v_and_b32 v61, 0xffff0000, v99
    v_fmac_f32 v58, v41, v60
    v_fmac_f32 v59, v41, v61
    v_lshlrev_b32 v60, 16, v100
    v_and_b32 v61, 0xffff0000, v100
    v_fmac_f32 v48, v42, v60
    v_fmac_f32 v49, v42, v61
    v_lshlrev_b32 v60, 16, v101
    v_and_b32 v61, 0xffff0000, v101
    v_fmac_f32 v50, v42, v60
    v_fmac_f32 v51, v42, v61
    v_lshlrev_b32 v60, 16, v102
    v_and_b32 v61, 0xffff0000, v102
    v_fmac_f32 v52, v42, v60
    v_fmac_f32 v53, v42, v61
    v_lshlrev_b32 v60, 16, v103
    v_and_b32 v61, 0xffff0000, v103
    v_fmac_f32 v54, v42, v60
    v_fmac_f32 v55, v42, v61
    v_lshlrev_b32 v60, 16, v104
    v_and_b32 v61, 0xffff0000, v104
    v_fmac_f32 v56, v42, v60
    v_fmac_f32 v57, v42, v61
    v_lshlrev_b32 v60, 16, v105
    v_and_b32 v61, 0xffff0000, v105
    v_fmac_f32 v58, v42, v60
    v_fmac_f32 v59, v42, v61
    v_lshlrev_b32 v60, 16, v106
    v_and_b32 v61, 0xffff0000, v106
    v_fmac_f32 v48, v43, v60
    v_fmac_f32 v49, v43, v61
    v_lshlrev_b32 v60, 16, v107
    v_and_b32 v61, 0xffff0000, v107
    v_fmac_f32 v50, v43, v60
    v_fmac_f32 v51, v43, v61
    v_lshlrev_b32 v60, 16, v108
    v_and_b32 v61, 0xffff0000, v108
    v_fmac_f32 v52, v43, v60
    v_fmac_f32 v53, v43, v61
    v_lshlrev_b32 v60, 16, v109
    v_and_b32 v61, 0xffff0000, v109
    v_fmac_f32 v54, v43, v60
    v_fmac_f32 v55, v43, v61
    v_lshlrev_b32 v60, 16, v110
    v_and_b32 v61, 0xffff0000, v110
    v_fmac_f32 v56, v43, v60
    v_fmac_f32 v57, v43, v61
    v_lshlrev_b32 v60, 16, v111
    v_and_b32 v61, 0xffff0000, v111
    v_fmac_f32 v58, v43, v60
    v_fmac_f32 v59, v43, v61
    s_mov_b32 s30, 147456
    buffer_load_dwordx4 v[64:67], v10, s[8:11], s30 offen offset:0 nt
    buffer_load_dwordx4 v[68:71], v10, s[8:11], s30 offen offset:64 nt
    buffer_load_dwordx4 v[72:75], v10, s[8:11], s30 offen offset:128 nt
    buffer_load_dwordx4 v[76:79], v10, s[8:11], s30 offen offset:192 nt
    buffer_load_dwordx4 v[80:83], v10, s[8:11], s30 offen offset:256 nt
    buffer_load_dwordx4 v[84:87], v10, s[8:11], s30 offen offset:320 nt
    buffer_load_dwordx4 v[88:91], v11, s[16:19], s30 offen offset:0 nt
    buffer_load_dwordx2 v[92:93], v12, s[16:19], s30 offen offset:0 nt
    buffer_load_dwordx4 v[94:97], v11, s[16:19], s30 offen offset:384 nt
    buffer_load_dwordx2 v[98:99], v12, s[16:19], s30 offen offset:384 nt
    buffer_load_dwordx4 v[100:103], v11, s[16:19], s30 offen offset:768 nt
    buffer_load_dwordx2 v[104:105], v12, s[16:19], s30 offen offset:768 nt
    buffer_load_dwordx4 v[106:109], v11, s[16:19], s30 offen offset:1152 nt
    buffer_load_dwordx2 v[110:111], v12, s[16:19], s30 offen offset:1152 nt
    s_waitcnt vmcnt(28)
    v_mov_b32 v40, 0
    v_mov_b32 v41, 0
    v_mov_b32 v42, 0
    v_mov_b32 v43, 0
    s_nop 1
    v_mfma_f32_16x16x32_bf16 v[40:43], v[112:115], v[16:19], v[40:43]
    v_mfma_f32_16x16x32_bf16 v[40:43], v[116:119], v[20:23], v[40:43]
    v_mfma_f32_16x16x32_bf16 v[40:43], v[120:123], v[24:27], v[40:43]
    v_mfma_f32_16x16x32_bf16 v[40:43], v[124:127], v[28:31], v[40:43]
    v_mfma_f32_16x16x32_bf16 v[40:43], v[128:131], v[32:35], v[40:43]
    v_mfma_f32_16x16x32_bf16 v[40:43], v[132:135], v[36:39], v[40:43]
    s_nop 9
    v_mul_f32 v40, s31, v40
    v_mul_f32 v41, s31, v41
    v_mul_f32 v42, s31, v42
    v_mul_f32 v43, s31, v43
    v_max3_f32 v46, v40, v41, v42
    v_max_f32 v46, v46, v43
    v_mov_b32 v60, v46
    v_mov_b32 v61, v46
    s_nop 1
    v_permlane32_swap_b32 v60, v61
    s_nop 1
    v_max_f32 v46, v60, v61
    v_mov_b32 v60, v46
    v_mov_b32 v61, v46
    s_nop 1
    v_permlane16_swap_b32 v60, v61
    s_nop 1
    v_max_f32 v46, v60, v61
    v_max_f32 v46, v46, v44
    v_sub_f32 v47, v44, v46
    v_exp_f32 v47, v47
    v_mov_b32 v44, v46
    v_sub_f32 v40, v40, v46
    v_sub_f32 v41, v41, v46
    v_sub_f32 v42, v42, v46
    v_sub_f32 v43, v43, v46
    v_exp_f32 v40, v40
    v_exp_f32 v41, v41
    v_exp_f32 v42, v42
    v_exp_f32 v43, v43
    v_mul_f32 v45, v45, v47
    v_mul_f32 v48, v48, v47
    v_mul_f32 v49, v49, v47
    v_mul_f32 v50, v50, v47
    v_mul_f32 v51, v51, v47
    v_mul_f32 v52, v52, v47
    v_mul_f32 v53, v53, v47
    v_mul_f32 v54, v54, v47
    v_mul_f32 v55, v55, v47
    v_mul_f32 v56, v56, v47
    v_mul_f32 v57, v57, v47
    v_mul_f32 v58, v58, v47
    v_mul_f32 v59, v59, v47
    v_add_f32 v45, v45, v40
    v_add_f32 v45, v45, v41
    v_add_f32 v45, v45, v42
    v_add_f32 v45, v45, v43
    v_lshlrev_b32 v60, 16, v136
    v_and_b32 v61, 0xffff0000, v136
    v_fmac_f32 v48, v40, v60
    v_fmac_f32 v49, v40, v61
    v_lshlrev_b32 v60, 16, v137
    v_and_b32 v61, 0xffff0000, v137
    v_fmac_f32 v50, v40, v60
    v_fmac_f32 v51, v40, v61
    v_lshlrev_b32 v60, 16, v138
    v_and_b32 v61, 0xffff0000, v138
    v_fmac_f32 v52, v40, v60
    v_fmac_f32 v53, v40, v61
    v_lshlrev_b32 v60, 16, v139
    v_and_b32 v61, 0xffff0000, v139
    v_fmac_f32 v54, v40, v60
    v_fmac_f32 v55, v40, v61
    v_lshlrev_b32 v60, 16, v140
    v_and_b32 v61, 0xffff0000, v140
    v_fmac_f32 v56, v40, v60
    v_fmac_f32 v57, v40, v61
    v_lshlrev_b32 v60, 16, v141
    v_and_b32 v61, 0xffff0000, v141
    v_fmac_f32 v58, v40, v60
    v_fmac_f32 v59, v40, v61
    v_lshlrev_b32 v60, 16, v142
    v_and_b32 v61, 0xffff0000, v142
    v_fmac_f32 v48, v41, v60
    v_fmac_f32 v49, v41, v61
    v_lshlrev_b32 v60, 16, v143
    v_and_b32 v61, 0xffff0000, v143
    v_fmac_f32 v50, v41, v60
    v_fmac_f32 v51, v41, v61
    v_lshlrev_b32 v60, 16, v144
    v_and_b32 v61, 0xffff0000, v144
    v_fmac_f32 v52, v41, v60
    v_fmac_f32 v53, v41, v61
    v_lshlrev_b32 v60, 16, v145
    v_and_b32 v61, 0xffff0000, v145
    v_fmac_f32 v54, v41, v60
    v_fmac_f32 v55, v41, v61
    v_lshlrev_b32 v60, 16, v146
    v_and_b32 v61, 0xffff0000, v146
    v_fmac_f32 v56, v41, v60
    v_fmac_f32 v57, v41, v61
    v_lshlrev_b32 v60, 16, v147
    v_and_b32 v61, 0xffff0000, v147
    v_fmac_f32 v58, v41, v60
    v_fmac_f32 v59, v41, v61
    v_lshlrev_b32 v60, 16, v148
    v_and_b32 v61, 0xffff0000, v148
    v_fmac_f32 v48, v42, v60
    v_fmac_f32 v49, v42, v61
    v_lshlrev_b32 v60, 16, v149
    v_and_b32 v61, 0xffff0000, v149
    v_fmac_f32 v50, v42, v60
    v_fmac_f32 v51, v42, v61
    v_lshlrev_b32 v60, 16, v150
    v_and_b32 v61, 0xffff0000, v150
    v_fmac_f32 v52, v42, v60
    v_fmac_f32 v53, v42, v61
    v_lshlrev_b32 v60, 16, v151
    v_and_b32 v61, 0xffff0000, v151
    v_fmac_f32 v54, v42, v60
    v_fmac_f32 v55, v42, v61
    v_lshlrev_b32 v60, 16, v152
    v_and_b32 v61, 0xffff0000, v152
    v_fmac_f32 v56, v42, v60
    v_fmac_f32 v57, v42, v61
    v_lshlrev_b32 v60, 16, v153
    v_and_b32 v61, 0xffff0000, v153
    v_fmac_f32 v58, v42, v60
    v_fmac_f32 v59, v42, v61
    v_lshlrev_b32 v60, 16, v154
    v_and_b32 v61, 0xffff0000, v154
    v_fmac_f32 v48, v43, v60
    v_fmac_f32 v49, v43, v61
    v_lshlrev_b32 v60, 16, v155
    v_and_b32 v61, 0xffff0000, v155
    v_fmac_f32 v50, v43, v60
    v_fmac_f32 v51, v43, v61
    v_lshlrev_b32 v60, 16, v156
    v_and_b32 v61, 0xffff0000, v156
    v_fmac_f32 v52, v43, v60
    v_fmac_f32 v53, v43, v61
    v_lshlrev_b32 v60, 16, v157
    v_and_b32 v61, 0xffff0000, v157
    v_fmac_f32 v54, v43, v60
    v_fmac_f32 v55, v43, v61
    v_lshlrev_b32 v60, 16, v158
    v_and_b32 v61, 0xffff0000, v158
    v_fmac_f32 v56, v43, v60
    v_fmac_f32 v57, v43, v61
    v_lshlrev_b32 v60, 16, v159
    v_and_b32 v61, 0xffff0000, v159
    v_fmac_f32 v58, v43, v60
    v_fmac_f32 v59, v43, v61
    s_mov_b32 s30, 172032
    buffer_load_dwordx4 v[112:115], v10, s[8:11], s30 offen offset:0 nt
    buffer_load_dwordx4 v[116:119], v10, s[8:11], s30 offen offset:64 nt
    buffer_load_dwordx4 v[120:123], v10, s[8:11], s30 offen offset:128 nt
    buffer_load_dwordx4 v[124:127], v10, s[8:11], s30 offen offset:192 nt
    buffer_load_dwordx4 v[128:131], v10, s[8:11], s30 offen offset:256 nt
    buffer_load_dwordx4 v[132:135], v10, s[8:11], s30 offen offset:320 nt
    buffer_load_dwordx4 v[136:139], v11, s[16:19], s30 offen offset:0 nt
    buffer_load_dwordx2 v[140:141], v12, s[16:19], s30 offen offset:0 nt
    buffer_load_dwordx4 v[142:145], v11, s[16:19], s30 offen offset:384 nt
    buffer_load_dwordx2 v[146:147], v12, s[16:19], s30 offen offset:384 nt
    buffer_load_dwordx4 v[148:151], v11, s[16:19], s30 offen offset:768 nt
    buffer_load_dwordx2 v[152:153], v12, s[16:19], s30 offen offset:768 nt
    buffer_load_dwordx4 v[154:157], v11, s[16:19], s30 offen offset:1152 nt
    buffer_load_dwordx2 v[158:159], v12, s[16:19], s30 offen offset:1152 nt
    s_waitcnt vmcnt(28)
    v_mov_b32 v40, 0
    v_mov_b32 v41, 0
    v_mov_b32 v42, 0
    v_mov_b32 v43, 0
    s_nop 1
    v_mfma_f32_16x16x32_bf16 v[40:43], v[160:163], v[16:19], v[40:43]
    v_mfma_f32_16x16x32_bf16 v[40:43], v[164:167], v[20:23], v[40:43]
    v_mfma_f32_16x16x32_bf16 v[40:43], v[168:171], v[24:27], v[40:43]
    v_mfma_f32_16x16x32_bf16 v[40:43], v[172:175], v[28:31], v[40:43]
    v_mfma_f32_16x16x32_bf16 v[40:43], v[176:179], v[32:35], v[40:43]
    v_mfma_f32_16x16x32_bf16 v[40:43], v[180:183], v[36:39], v[40:43]
    s_nop 9
    v_mul_f32 v40, s31, v40
    v_mul_f32 v41, s31, v41
    v_mul_f32 v42, s31, v42
    v_mul_f32 v43, s31, v43
    v_max3_f32 v46, v40, v41, v42
    v_max_f32 v46, v46, v43
    v_mov_b32 v60, v46
    v_mov_b32 v61, v46
    s_nop 1
    v_permlane32_swap_b32 v60, v61
    s_nop 1
    v_max_f32 v46, v60, v61
    v_mov_b32 v60, v46
    v_mov_b32 v61, v46
    s_nop 1
    v_permlane16_swap_b32 v60, v61
    s_nop 1
    v_max_f32 v46, v60, v61
    v_max_f32 v46, v46, v44
    v_sub_f32 v47, v44, v46
    v_exp_f32 v47, v47
    v_mov_b32 v44, v46
    v_sub_f32 v40, v40, v46
    v_sub_f32 v41, v41, v46
    v_sub_f32 v42, v42, v46
    v_sub_f32 v43, v43, v46
    v_exp_f32 v40, v40
    v_exp_f32 v41, v41
    v_exp_f32 v42, v42
    v_exp_f32 v43, v43
    v_mul_f32 v45, v45, v47
    v_mul_f32 v48, v48, v47
    v_mul_f32 v49, v49, v47
    v_mul_f32 v50, v50, v47
    v_mul_f32 v51, v51, v47
    v_mul_f32 v52, v52, v47
    v_mul_f32 v53, v53, v47
    v_mul_f32 v54, v54, v47
    v_mul_f32 v55, v55, v47
    v_mul_f32 v56, v56, v47
    v_mul_f32 v57, v57, v47
    v_mul_f32 v58, v58, v47
    v_mul_f32 v59, v59, v47
    v_add_f32 v45, v45, v40
    v_add_f32 v45, v45, v41
    v_add_f32 v45, v45, v42
    v_add_f32 v45, v45, v43
    v_lshlrev_b32 v60, 16, v184
    v_and_b32 v61, 0xffff0000, v184
    v_fmac_f32 v48, v40, v60
    v_fmac_f32 v49, v40, v61
    v_lshlrev_b32 v60, 16, v185
    v_and_b32 v61, 0xffff0000, v185
    v_fmac_f32 v50, v40, v60
    v_fmac_f32 v51, v40, v61
    v_lshlrev_b32 v60, 16, v186
    v_and_b32 v61, 0xffff0000, v186
    v_fmac_f32 v52, v40, v60
    v_fmac_f32 v53, v40, v61
    v_lshlrev_b32 v60, 16, v187
    v_and_b32 v61, 0xffff0000, v187
    v_fmac_f32 v54, v40, v60
    v_fmac_f32 v55, v40, v61
    v_lshlrev_b32 v60, 16, v188
    v_and_b32 v61, 0xffff0000, v188
    v_fmac_f32 v56, v40, v60
    v_fmac_f32 v57, v40, v61
    v_lshlrev_b32 v60, 16, v189
    v_and_b32 v61, 0xffff0000, v189
    v_fmac_f32 v58, v40, v60
    v_fmac_f32 v59, v40, v61
    v_lshlrev_b32 v60, 16, v190
    v_and_b32 v61, 0xffff0000, v190
    v_fmac_f32 v48, v41, v60
    v_fmac_f32 v49, v41, v61
    v_lshlrev_b32 v60, 16, v191
    v_and_b32 v61, 0xffff0000, v191
    v_fmac_f32 v50, v41, v60
    v_fmac_f32 v51, v41, v61
    v_lshlrev_b32 v60, 16, v192
    v_and_b32 v61, 0xffff0000, v192
    v_fmac_f32 v52, v41, v60
    v_fmac_f32 v53, v41, v61
    v_lshlrev_b32 v60, 16, v193
    v_and_b32 v61, 0xffff0000, v193
    v_fmac_f32 v54, v41, v60
    v_fmac_f32 v55, v41, v61
    v_lshlrev_b32 v60, 16, v194
    v_and_b32 v61, 0xffff0000, v194
    v_fmac_f32 v56, v41, v60
    v_fmac_f32 v57, v41, v61
    v_lshlrev_b32 v60, 16, v195
    v_and_b32 v61, 0xffff0000, v195
    v_fmac_f32 v58, v41, v60
    v_fmac_f32 v59, v41, v61
    v_lshlrev_b32 v60, 16, v196
    v_and_b32 v61, 0xffff0000, v196
    v_fmac_f32 v48, v42, v60
    v_fmac_f32 v49, v42, v61
    v_lshlrev_b32 v60, 16, v197
    v_and_b32 v61, 0xffff0000, v197
    v_fmac_f32 v50, v42, v60
    v_fmac_f32 v51, v42, v61
    v_lshlrev_b32 v60, 16, v198
    v_and_b32 v61, 0xffff0000, v198
    v_fmac_f32 v52, v42, v60
    v_fmac_f32 v53, v42, v61
    v_lshlrev_b32 v60, 16, v199
    v_and_b32 v61, 0xffff0000, v199
    v_fmac_f32 v54, v42, v60
    v_fmac_f32 v55, v42, v61
    v_lshlrev_b32 v60, 16, v200
    v_and_b32 v61, 0xffff0000, v200
    v_fmac_f32 v56, v42, v60
    v_fmac_f32 v57, v42, v61
    v_lshlrev_b32 v60, 16, v201
    v_and_b32 v61, 0xffff0000, v201
    v_fmac_f32 v58, v42, v60
    v_fmac_f32 v59, v42, v61
    v_lshlrev_b32 v60, 16, v202
    v_and_b32 v61, 0xffff0000, v202
    v_fmac_f32 v48, v43, v60
    v_fmac_f32 v49, v43, v61
    v_lshlrev_b32 v60, 16, v203
    v_and_b32 v61, 0xffff0000, v203
    v_fmac_f32 v50, v43, v60
    v_fmac_f32 v51, v43, v61
    v_lshlrev_b32 v60, 16, v204
    v_and_b32 v61, 0xffff0000, v204
    v_fmac_f32 v52, v43, v60
    v_fmac_f32 v53, v43, v61
    v_lshlrev_b32 v60, 16, v205
    v_and_b32 v61, 0xffff0000, v205
    v_fmac_f32 v54, v43, v60
    v_fmac_f32 v55, v43, v61
    v_lshlrev_b32 v60, 16, v206
    v_and_b32 v61, 0xffff0000, v206
    v_fmac_f32 v56, v43, v60
    v_fmac_f32 v57, v43, v61
    v_lshlrev_b32 v60, 16, v207
    v_and_b32 v61, 0xffff0000, v207
    v_fmac_f32 v58, v43, v60
    v_fmac_f32 v59, v43, v61
    s_mov_b32 s30, 196608
    buffer_load_dwordx4 v[160:163], v10, s[8:11], s30 offen offset:0 nt
    buffer_load_dwordx4 v[164:167], v10, s[8:11], s30 offen offset:64 nt
    buffer_load_dwordx4 v[168:171], v10, s[8:11], s30 offen offset:128 nt
    buffer_load_dwordx4 v[172:175], v10, s[8:11], s30 offen offset:192 nt
    buffer_load_dwordx4 v[176:179], v10, s[8:11], s30 offen offset:256 nt
    buffer_load_dwordx4 v[180:183], v10, s[8:11], s30 offen offset:320 nt
    buffer_load_dwordx4 v[184:187], v11, s[16:19], s30 offen offset:0 nt
    buffer_load_dwordx2 v[188:189], v12, s[16:19], s30 offen offset:0 nt
    buffer_load_dwordx4 v[190:193], v11, s[16:19], s30 offen offset:384 nt
    buffer_load_dwordx2 v[194:195], v12, s[16:19], s30 offen offset:384 nt
    buffer_load_dwordx4 v[196:199], v11, s[16:19], s30 offen offset:768 nt
    buffer_load_dwordx2 v[200:201], v12, s[16:19], s30 offen offset:768 nt
    buffer_load_dwordx4 v[202:205], v11, s[16:19], s30 offen offset:1152 nt
    buffer_load_dwordx2 v[206:207], v12, s[16:19], s30 offen offset:1152 nt
    s_waitcnt vmcnt(28)
    v_mov_b32 v40, 0
    v_mov_b32 v41, 0
    v_mov_b32 v42, 0
    v_mov_b32 v43, 0
    s_nop 1
    v_mfma_f32_16x16x32_bf16 v[40:43], v[64:67], v[16:19], v[40:43]
    v_mfma_f32_16x16x32_bf16 v[40:43], v[68:71], v[20:23], v[40:43]
    v_mfma_f32_16x16x32_bf16 v[40:43], v[72:75], v[24:27], v[40:43]
    v_mfma_f32_16x16x32_bf16 v[40:43], v[76:79], v[28:31], v[40:43]
    v_mfma_f32_16x16x32_bf16 v[40:43], v[80:83], v[32:35], v[40:43]
    v_mfma_f32_16x16x32_bf16 v[40:43], v[84:87], v[36:39], v[40:43]
    s_nop 9
    v_mul_f32 v40, s31, v40
    v_mul_f32 v41, s31, v41
    v_mul_f32 v42, s31, v42
    v_mul_f32 v43, s31, v43
    v_max3_f32 v46, v40, v41, v42
    v_max_f32 v46, v46, v43
    v_mov_b32 v60, v46
    v_mov_b32 v61, v46
    s_nop 1
    v_permlane32_swap_b32 v60, v61
    s_nop 1
    v_max_f32 v46, v60, v61
    v_mov_b32 v60, v46
    v_mov_b32 v61, v46
    s_nop 1
    v_permlane16_swap_b32 v60, v61
    s_nop 1
    v_max_f32 v46, v60, v61
    v_max_f32 v46, v46, v44
    v_sub_f32 v47, v44, v46
    v_exp_f32 v47, v47
    v_mov_b32 v44, v46
    v_sub_f32 v40, v40, v46
    v_sub_f32 v41, v41, v46
    v_sub_f32 v42, v42, v46
    v_sub_f32 v43, v43, v46
    v_exp_f32 v40, v40
    v_exp_f32 v41, v41
    v_exp_f32 v42, v42
    v_exp_f32 v43, v43
    v_mul_f32 v45, v45, v47
    v_mul_f32 v48, v48, v47
    v_mul_f32 v49, v49, v47
    v_mul_f32 v50, v50, v47
    v_mul_f32 v51, v51, v47
    v_mul_f32 v52, v52, v47
    v_mul_f32 v53, v53, v47
    v_mul_f32 v54, v54, v47
    v_mul_f32 v55, v55, v47
    v_mul_f32 v56, v56, v47
    v_mul_f32 v57, v57, v47
    v_mul_f32 v58, v58, v47
    v_mul_f32 v59, v59, v47
    v_add_f32 v45, v45, v40
    v_add_f32 v45, v45, v41
    v_add_f32 v45, v45, v42
    v_add_f32 v45, v45, v43
    v_lshlrev_b32 v60, 16, v88
    v_and_b32 v61, 0xffff0000, v88
    v_fmac_f32 v48, v40, v60
    v_fmac_f32 v49, v40, v61
    v_lshlrev_b32 v60, 16, v89
    v_and_b32 v61, 0xffff0000, v89
    v_fmac_f32 v50, v40, v60
    v_fmac_f32 v51, v40, v61
    v_lshlrev_b32 v60, 16, v90
    v_and_b32 v61, 0xffff0000, v90
    v_fmac_f32 v52, v40, v60
    v_fmac_f32 v53, v40, v61
    v_lshlrev_b32 v60, 16, v91
    v_and_b32 v61, 0xffff0000, v91
    v_fmac_f32 v54, v40, v60
    v_fmac_f32 v55, v40, v61
    v_lshlrev_b32 v60, 16, v92
    v_and_b32 v61, 0xffff0000, v92
    v_fmac_f32 v56, v40, v60
    v_fmac_f32 v57, v40, v61
    v_lshlrev_b32 v60, 16, v93
    v_and_b32 v61, 0xffff0000, v93
    v_fmac_f32 v58, v40, v60
    v_fmac_f32 v59, v40, v61
    v_lshlrev_b32 v60, 16, v94
    v_and_b32 v61, 0xffff0000, v94
    v_fmac_f32 v48, v41, v60
    v_fmac_f32 v49, v41, v61
    v_lshlrev_b32 v60, 16, v95
    v_and_b32 v61, 0xffff0000, v95
    v_fmac_f32 v50, v41, v60
    v_fmac_f32 v51, v41, v61
    v_lshlrev_b32 v60, 16, v96
    v_and_b32 v61, 0xffff0000, v96
    v_fmac_f32 v52, v41, v60
    v_fmac_f32 v53, v41, v61
    v_lshlrev_b32 v60, 16, v97
    v_and_b32 v61, 0xffff0000, v97
    v_fmac_f32 v54, v41, v60
    v_fmac_f32 v55, v41, v61
    v_lshlrev_b32 v60, 16, v98
    v_and_b32 v61, 0xffff0000, v98
    v_fmac_f32 v56, v41, v60
    v_fmac_f32 v57, v41, v61
    v_lshlrev_b32 v60, 16, v99
    v_and_b32 v61, 0xffff0000, v99
    v_fmac_f32 v58, v41, v60
    v_fmac_f32 v59, v41, v61
    v_lshlrev_b32 v60, 16, v100
    v_and_b32 v61, 0xffff0000, v100
    v_fmac_f32 v48, v42, v60
    v_fmac_f32 v49, v42, v61
    v_lshlrev_b32 v60, 16, v101
    v_and_b32 v61, 0xffff0000, v101
    v_fmac_f32 v50, v42, v60
    v_fmac_f32 v51, v42, v61
    v_lshlrev_b32 v60, 16, v102
    v_and_b32 v61, 0xffff0000, v102
    v_fmac_f32 v52, v42, v60
    v_fmac_f32 v53, v42, v61
    v_lshlrev_b32 v60, 16, v103
    v_and_b32 v61, 0xffff0000, v103
    v_fmac_f32 v54, v42, v60
    v_fmac_f32 v55, v42, v61
    v_lshlrev_b32 v60, 16, v104
    v_and_b32 v61, 0xffff0000, v104
    v_fmac_f32 v56, v42, v60
    v_fmac_f32 v57, v42, v61
    v_lshlrev_b32 v60, 16, v105
    v_and_b32 v61, 0xffff0000, v105
    v_fmac_f32 v58, v42, v60
    v_fmac_f32 v59, v42, v61
    v_lshlrev_b32 v60, 16, v106
    v_and_b32 v61, 0xffff0000, v106
    v_fmac_f32 v48, v43, v60
    v_fmac_f32 v49, v43, v61
    v_lshlrev_b32 v60, 16, v107
    v_and_b32 v61, 0xffff0000, v107
    v_fmac_f32 v50, v43, v60
    v_fmac_f32 v51, v43, v61
    v_lshlrev_b32 v60, 16, v108
    v_and_b32 v61, 0xffff0000, v108
    v_fmac_f32 v52, v43, v60
    v_fmac_f32 v53, v43, v61
    v_lshlrev_b32 v60, 16, v109
    v_and_b32 v61, 0xffff0000, v109
    v_fmac_f32 v54, v43, v60
    v_fmac_f32 v55, v43, v61
    v_lshlrev_b32 v60, 16, v110
    v_and_b32 v61, 0xffff0000, v110
    v_fmac_f32 v56, v43, v60
    v_fmac_f32 v57, v43, v61
    v_lshlrev_b32 v60, 16, v111
    v_and_b32 v61, 0xffff0000, v111
    v_fmac_f32 v58, v43, v60
    v_fmac_f32 v59, v43, v61
    s_mov_b32 s30, 221184
    buffer_load_dwordx4 v[64:67], v10, s[8:11], s30 offen offset:0 nt
    buffer_load_dwordx4 v[68:71], v10, s[8:11], s30 offen offset:64 nt
    buffer_load_dwordx4 v[72:75], v10, s[8:11], s30 offen offset:128 nt
    buffer_load_dwordx4 v[76:79], v10, s[8:11], s30 offen offset:192 nt
    buffer_load_dwordx4 v[80:83], v10, s[8:11], s30 offen offset:256 nt
    buffer_load_dwordx4 v[84:87], v10, s[8:11], s30 offen offset:320 nt
    buffer_load_dwordx4 v[88:91], v11, s[16:19], s30 offen offset:0 nt
    buffer_load_dwordx2 v[92:93], v12, s[16:19], s30 offen offset:0 nt
    buffer_load_dwordx4 v[94:97], v11, s[16:19], s30 offen offset:384 nt
    buffer_load_dwordx2 v[98:99], v12, s[16:19], s30 offen offset:384 nt
    buffer_load_dwordx4 v[100:103], v11, s[16:19], s30 offen offset:768 nt
    buffer_load_dwordx2 v[104:105], v12, s[16:19], s30 offen offset:768 nt
    buffer_load_dwordx4 v[106:109], v11, s[16:19], s30 offen offset:1152 nt
    buffer_load_dwordx2 v[110:111], v12, s[16:19], s30 offen offset:1152 nt
    s_waitcnt vmcnt(28)
    v_mov_b32 v40, 0
    v_mov_b32 v41, 0
    v_mov_b32 v42, 0
    v_mov_b32 v43, 0
    s_nop 1
    v_mfma_f32_16x16x32_bf16 v[40:43], v[112:115], v[16:19], v[40:43]
    v_mfma_f32_16x16x32_bf16 v[40:43], v[116:119], v[20:23], v[40:43]
    v_mfma_f32_16x16x32_bf16 v[40:43], v[120:123], v[24:27], v[40:43]
    v_mfma_f32_16x16x32_bf16 v[40:43], v[124:127], v[28:31], v[40:43]
    v_mfma_f32_16x16x32_bf16 v[40:43], v[128:131], v[32:35], v[40:43]
    v_mfma_f32_16x16x32_bf16 v[40:43], v[132:135], v[36:39], v[40:43]
    s_nop 9
    v_mul_f32 v40, s31, v40
    v_mul_f32 v41, s31, v41
    v_mul_f32 v42, s31, v42
    v_mul_f32 v43, s31, v43
    v_max3_f32 v46, v40, v41, v42
    v_max_f32 v46, v46, v43
    v_mov_b32 v60, v46
    v_mov_b32 v61, v46
    s_nop 1
    v_permlane32_swap_b32 v60, v61
    s_nop 1
    v_max_f32 v46, v60, v61
    v_mov_b32 v60, v46
    v_mov_b32 v61, v46
    s_nop 1
    v_permlane16_swap_b32 v60, v61
    s_nop 1
    v_max_f32 v46, v60, v61
    v_max_f32 v46, v46, v44
    v_sub_f32 v47, v44, v46
    v_exp_f32 v47, v47
    v_mov_b32 v44, v46
    v_sub_f32 v40, v40, v46
    v_sub_f32 v41, v41, v46
    v_sub_f32 v42, v42, v46
    v_sub_f32 v43, v43, v46
    v_exp_f32 v40, v40
    v_exp_f32 v41, v41
    v_exp_f32 v42, v42
    v_exp_f32 v43, v43
    v_mul_f32 v45, v45, v47
    v_mul_f32 v48, v48, v47
    v_mul_f32 v49, v49, v47
    v_mul_f32 v50, v50, v47
    v_mul_f32 v51, v51, v47
    v_mul_f32 v52, v52, v47
    v_mul_f32 v53, v53, v47
    v_mul_f32 v54, v54, v47
    v_mul_f32 v55, v55, v47
    v_mul_f32 v56, v56, v47
    v_mul_f32 v57, v57, v47
    v_mul_f32 v58, v58, v47
    v_mul_f32 v59, v59, v47
    v_add_f32 v45, v45, v40
    v_add_f32 v45, v45, v41
    v_add_f32 v45, v45, v42
    v_add_f32 v45, v45, v43
    v_lshlrev_b32 v60, 16, v136
    v_and_b32 v61, 0xffff0000, v136
    v_fmac_f32 v48, v40, v60
    v_fmac_f32 v49, v40, v61
    v_lshlrev_b32 v60, 16, v137
    v_and_b32 v61, 0xffff0000, v137
    v_fmac_f32 v50, v40, v60
    v_fmac_f32 v51, v40, v61
    v_lshlrev_b32 v60, 16, v138
    v_and_b32 v61, 0xffff0000, v138
    v_fmac_f32 v52, v40, v60
    v_fmac_f32 v53, v40, v61
    v_lshlrev_b32 v60, 16, v139
    v_and_b32 v61, 0xffff0000, v139
    v_fmac_f32 v54, v40, v60
    v_fmac_f32 v55, v40, v61
    v_lshlrev_b32 v60, 16, v140
    v_and_b32 v61, 0xffff0000, v140
    v_fmac_f32 v56, v40, v60
    v_fmac_f32 v57, v40, v61
    v_lshlrev_b32 v60, 16, v141
    v_and_b32 v61, 0xffff0000, v141
    v_fmac_f32 v58, v40, v60
    v_fmac_f32 v59, v40, v61
    v_lshlrev_b32 v60, 16, v142
    v_and_b32 v61, 0xffff0000, v142
    v_fmac_f32 v48, v41, v60
    v_fmac_f32 v49, v41, v61
    v_lshlrev_b32 v60, 16, v143
    v_and_b32 v61, 0xffff0000, v143
    v_fmac_f32 v50, v41, v60
    v_fmac_f32 v51, v41, v61
    v_lshlrev_b32 v60, 16, v144
    v_and_b32 v61, 0xffff0000, v144
    v_fmac_f32 v52, v41, v60
    v_fmac_f32 v53, v41, v61
    v_lshlrev_b32 v60, 16, v145
    v_and_b32 v61, 0xffff0000, v145
    v_fmac_f32 v54, v41, v60
    v_fmac_f32 v55, v41, v61
    v_lshlrev_b32 v60, 16, v146
    v_and_b32 v61, 0xffff0000, v146
    v_fmac_f32 v56, v41, v60
    v_fmac_f32 v57, v41, v61
    v_lshlrev_b32 v60, 16, v147
    v_and_b32 v61, 0xffff0000, v147
    v_fmac_f32 v58, v41, v60
    v_fmac_f32 v59, v41, v61
    v_lshlrev_b32 v60, 16, v148
    v_and_b32 v61, 0xffff0000, v148
    v_fmac_f32 v48, v42, v60
    v_fmac_f32 v49, v42, v61
    v_lshlrev_b32 v60, 16, v149
    v_and_b32 v61, 0xffff0000, v149
    v_fmac_f32 v50, v42, v60
    v_fmac_f32 v51, v42, v61
    v_lshlrev_b32 v60, 16, v150
    v_and_b32 v61, 0xffff0000, v150
    v_fmac_f32 v52, v42, v60
    v_fmac_f32 v53, v42, v61
    v_lshlrev_b32 v60, 16, v151
    v_and_b32 v61, 0xffff0000, v151
    v_fmac_f32 v54, v42, v60
    v_fmac_f32 v55, v42, v61
    v_lshlrev_b32 v60, 16, v152
    v_and_b32 v61, 0xffff0000, v152
    v_fmac_f32 v56, v42, v60
    v_fmac_f32 v57, v42, v61
    v_lshlrev_b32 v60, 16, v153
    v_and_b32 v61, 0xffff0000, v153
    v_fmac_f32 v58, v42, v60
    v_fmac_f32 v59, v42, v61
    v_lshlrev_b32 v60, 16, v154
    v_and_b32 v61, 0xffff0000, v154
    v_fmac_f32 v48, v43, v60
    v_fmac_f32 v49, v43, v61
    v_lshlrev_b32 v60, 16, v155
    v_and_b32 v61, 0xffff0000, v155
    v_fmac_f32 v50, v43, v60
    v_fmac_f32 v51, v43, v61
    v_lshlrev_b32 v60, 16, v156
    v_and_b32 v61, 0xffff0000, v156
    v_fmac_f32 v52, v43, v60
    v_fmac_f32 v53, v43, v61
    v_lshlrev_b32 v60, 16, v157
    v_and_b32 v61, 0xffff0000, v157
    v_fmac_f32 v54, v43, v60
    v_fmac_f32 v55, v43, v61
    v_lshlrev_b32 v60, 16, v158
    v_and_b32 v61, 0xffff0000, v158
    v_fmac_f32 v56, v43, v60
    v_fmac_f32 v57, v43, v61
    v_lshlrev_b32 v60, 16, v159
    v_and_b32 v61, 0xffff0000, v159
    v_fmac_f32 v58, v43, v60
    v_fmac_f32 v59, v43, v61
    s_mov_b32 s30, 245760
    buffer_load_dwordx4 v[112:115], v10, s[8:11], s30 offen offset:0 nt
    buffer_load_dwordx4 v[116:119], v10, s[8:11], s30 offen offset:64 nt
    buffer_load_dwordx4 v[120:123], v10, s[8:11], s30 offen offset:128 nt
    buffer_load_dwordx4 v[124:127], v10, s[8:11], s30 offen offset:192 nt
    buffer_load_dwordx4 v[128:131], v10, s[8:11], s30 offen offset:256 nt
    buffer_load_dwordx4 v[132:135], v10, s[8:11], s30 offen offset:320 nt
    buffer_load_dwordx4 v[136:139], v11, s[16:19], s30 offen offset:0 nt
    buffer_load_dwordx2 v[140:141], v12, s[16:19], s30 offen offset:0 nt
    buffer_load_dwordx4 v[142:145], v11, s[16:19], s30 offen offset:384 nt
    buffer_load_dwordx2 v[146:147], v12, s[16:19], s30 offen offset:384 nt
    buffer_load_dwordx4 v[148:151], v11, s[16:19], s30 offen offset:768 nt
    buffer_load_dwordx2 v[152:153], v12, s[16:19], s30 offen offset:768 nt
    buffer_load_dwordx4 v[154:157], v11, s[16:19], s30 offen offset:1152 nt
    buffer_load_dwordx2 v[158:159], v12, s[16:19], s30 offen offset:1152 nt
    s_waitcnt vmcnt(28)
    v_mov_b32 v40, 0
    v_mov_b32 v41, 0
    v_mov_b32 v42, 0
    v_mov_b32 v43, 0
    s_nop 1
    v_mfma_f32_16x16x32_bf16 v[40:43], v[160:163], v[16:19], v[40:43]
    v_mfma_f32_16x16x32_bf16 v[40:43], v[164:167], v[20:23], v[40:43]
    v_mfma_f32_16x16x32_bf16 v[40:43], v[168:171], v[24:27], v[40:43]
    v_mfma_f32_16x16x32_bf16 v[40:43], v[172:175], v[28:31], v[40:43]
    v_mfma_f32_16x16x32_bf16 v[40:43], v[176:179], v[32:35], v[40:43]
    v_mfma_f32_16x16x32_bf16 v[40:43], v[180:183], v[36:39], v[40:43]
    s_nop 9
    v_mul_f32 v40, s31, v40
    v_mul_f32 v41, s31, v41
    v_mul_f32 v42, s31, v42
    v_mul_f32 v43, s31, v43
    v_max3_f32 v46, v40, v41, v42
    v_max_f32 v46, v46, v43
    v_mov_b32 v60, v46
    v_mov_b32 v61, v46
    s_nop 1
    v_permlane32_swap_b32 v60, v61
    s_nop 1
    v_max_f32 v46, v60, v61
    v_mov_b32 v60, v46
    v_mov_b32 v61, v46
    s_nop 1
    v_permlane16_swap_b32 v60, v61
    s_nop 1
    v_max_f32 v46, v60, v61
    v_max_f32 v46, v46, v44
    v_sub_f32 v47, v44, v46
    v_exp_f32 v47, v47
    v_mov_b32 v44, v46
    v_sub_f32 v40, v40, v46
    v_sub_f32 v41, v41, v46
    v_sub_f32 v42, v42, v46
    v_sub_f32 v43, v43, v46
    v_exp_f32 v40, v40
    v_exp_f32 v41, v41
    v_exp_f32 v42, v42
    v_exp_f32 v43, v43
    v_mul_f32 v45, v45, v47
    v_mul_f32 v48, v48, v47
    v_mul_f32 v49, v49, v47
    v_mul_f32 v50, v50, v47
    v_mul_f32 v51, v51, v47
    v_mul_f32 v52, v52, v47
    v_mul_f32 v53, v53, v47
    v_mul_f32 v54, v54, v47
    v_mul_f32 v55, v55, v47
    v_mul_f32 v56, v56, v47
    v_mul_f32 v57, v57, v47
    v_mul_f32 v58, v58, v47
    v_mul_f32 v59, v59, v47
    v_add_f32 v45, v45, v40
    v_add_f32 v45, v45, v41
    v_add_f32 v45, v45, v42
    v_add_f32 v45, v45, v43
    v_lshlrev_b32 v60, 16, v184
    v_and_b32 v61, 0xffff0000, v184
    v_fmac_f32 v48, v40, v60
    v_fmac_f32 v49, v40, v61
    v_lshlrev_b32 v60, 16, v185
    v_and_b32 v61, 0xffff0000, v185
    v_fmac_f32 v50, v40, v60
    v_fmac_f32 v51, v40, v61
    v_lshlrev_b32 v60, 16, v186
    v_and_b32 v61, 0xffff0000, v186
    v_fmac_f32 v52, v40, v60
    v_fmac_f32 v53, v40, v61
    v_lshlrev_b32 v60, 16, v187
    v_and_b32 v61, 0xffff0000, v187
    v_fmac_f32 v54, v40, v60
    v_fmac_f32 v55, v40, v61
    v_lshlrev_b32 v60, 16, v188
    v_and_b32 v61, 0xffff0000, v188
    v_fmac_f32 v56, v40, v60
    v_fmac_f32 v57, v40, v61
    v_lshlrev_b32 v60, 16, v189
    v_and_b32 v61, 0xffff0000, v189
    v_fmac_f32 v58, v40, v60
    v_fmac_f32 v59, v40, v61
    v_lshlrev_b32 v60, 16, v190
    v_and_b32 v61, 0xffff0000, v190
    v_fmac_f32 v48, v41, v60
    v_fmac_f32 v49, v41, v61
    v_lshlrev_b32 v60, 16, v191
    v_and_b32 v61, 0xffff0000, v191
    v_fmac_f32 v50, v41, v60
    v_fmac_f32 v51, v41, v61
    v_lshlrev_b32 v60, 16, v192
    v_and_b32 v61, 0xffff0000, v192
    v_fmac_f32 v52, v41, v60
    v_fmac_f32 v53, v41, v61
    v_lshlrev_b32 v60, 16, v193
    v_and_b32 v61, 0xffff0000, v193
    v_fmac_f32 v54, v41, v60
    v_fmac_f32 v55, v41, v61
    v_lshlrev_b32 v60, 16, v194
    v_and_b32 v61, 0xffff0000, v194
    v_fmac_f32 v56, v41, v60
    v_fmac_f32 v57, v41, v61
    v_lshlrev_b32 v60, 16, v195
    v_and_b32 v61, 0xffff0000, v195
    v_fmac_f32 v58, v41, v60
    v_fmac_f32 v59, v41, v61
    v_lshlrev_b32 v60, 16, v196
    v_and_b32 v61, 0xffff0000, v196
    v_fmac_f32 v48, v42, v60
    v_fmac_f32 v49, v42, v61
    v_lshlrev_b32 v60, 16, v197
    v_and_b32 v61, 0xffff0000, v197
    v_fmac_f32 v50, v42, v60
    v_fmac_f32 v51, v42, v61
    v_lshlrev_b32 v60, 16, v198
    v_and_b32 v61, 0xffff0000, v198
    v_fmac_f32 v52, v42, v60
    v_fmac_f32 v53, v42, v61
    v_lshlrev_b32 v60, 16, v199
    v_and_b32 v61, 0xffff0000, v199
    v_fmac_f32 v54, v42, v60
    v_fmac_f32 v55, v42, v61
    v_lshlrev_b32 v60, 16, v200
    v_and_b32 v61, 0xffff0000, v200
    v_fmac_f32 v56, v42, v60
    v_fmac_f32 v57, v42, v61
    v_lshlrev_b32 v60, 16, v201
    v_and_b32 v61, 0xffff0000, v201
    v_fmac_f32 v58, v42, v60
    v_fmac_f32 v59, v42, v61
    v_lshlrev_b32 v60, 16, v202
    v_and_b32 v61, 0xffff0000, v202
    v_fmac_f32 v48, v43, v60
    v_fmac_f32 v49, v43, v61
    v_lshlrev_b32 v60, 16, v203
    v_and_b32 v61, 0xffff0000, v203
    v_fmac_f32 v50, v43, v60
    v_fmac_f32 v51, v43, v61
    v_lshlrev_b32 v60, 16, v204
    v_and_b32 v61, 0xffff0000, v204
    v_fmac_f32 v52, v43, v60
    v_fmac_f32 v53, v43, v61
    v_lshlrev_b32 v60, 16, v205
    v_and_b32 v61, 0xffff0000, v205
    v_fmac_f32 v54, v43, v60
    v_fmac_f32 v55, v43, v61
    v_lshlrev_b32 v60, 16, v206
    v_and_b32 v61, 0xffff0000, v206
    v_fmac_f32 v56, v43, v60
    v_fmac_f32 v57, v43, v61
    v_lshlrev_b32 v60, 16, v207
    v_and_b32 v61, 0xffff0000, v207
    v_fmac_f32 v58, v43, v60
    v_fmac_f32 v59, v43, v61
    s_mov_b32 s30, 270336
    buffer_load_dwordx4 v[160:163], v10, s[8:11], s30 offen offset:0 nt
    buffer_load_dwordx4 v[164:167], v10, s[8:11], s30 offen offset:64 nt
    buffer_load_dwordx4 v[168:171], v10, s[8:11], s30 offen offset:128 nt
    buffer_load_dwordx4 v[172:175], v10, s[8:11], s30 offen offset:192 nt
    buffer_load_dwordx4 v[176:179], v10, s[8:11], s30 offen offset:256 nt
    buffer_load_dwordx4 v[180:183], v10, s[8:11], s30 offen offset:320 nt
    buffer_load_dwordx4 v[184:187], v11, s[16:19], s30 offen offset:0 nt
    buffer_load_dwordx2 v[188:189], v12, s[16:19], s30 offen offset:0 nt
    buffer_load_dwordx4 v[190:193], v11, s[16:19], s30 offen offset:384 nt
    buffer_load_dwordx2 v[194:195], v12, s[16:19], s30 offen offset:384 nt
    buffer_load_dwordx4 v[196:199], v11, s[16:19], s30 offen offset:768 nt
    buffer_load_dwordx2 v[200:201], v12, s[16:19], s30 offen offset:768 nt
    buffer_load_dwordx4 v[202:205], v11, s[16:19], s30 offen offset:1152 nt
    buffer_load_dwordx2 v[206:207], v12, s[16:19], s30 offen offset:1152 nt
    s_waitcnt vmcnt(28)
    v_mov_b32 v40, 0
    v_mov_b32 v41, 0
    v_mov_b32 v42, 0
    v_mov_b32 v43, 0
    s_nop 1
    v_mfma_f32_16x16x32_bf16 v[40:43], v[64:67], v[16:19], v[40:43]
    v_mfma_f32_16x16x32_bf16 v[40:43], v[68:71], v[20:23], v[40:43]
    v_mfma_f32_16x16x32_bf16 v[40:43], v[72:75], v[24:27], v[40:43]
    v_mfma_f32_16x16x32_bf16 v[40:43], v[76:79], v[28:31], v[40:43]
    v_mfma_f32_16x16x32_bf16 v[40:43], v[80:83], v[32:35], v[40:43]
    v_mfma_f32_16x16x32_bf16 v[40:43], v[84:87], v[36:39], v[40:43]
    s_nop 9
    v_mul_f32 v40, s31, v40
    v_mul_f32 v41, s31, v41
    v_mul_f32 v42, s31, v42
    v_mul_f32 v43, s31, v43
    v_max3_f32 v46, v40, v41, v42
    v_max_f32 v46, v46, v43
    v_mov_b32 v60, v46
    v_mov_b32 v61, v46
    s_nop 1
    v_permlane32_swap_b32 v60, v61
    s_nop 1
    v_max_f32 v46, v60, v61
    v_mov_b32 v60, v46
    v_mov_b32 v61, v46
    s_nop 1
    v_permlane16_swap_b32 v60, v61
    s_nop 1
    v_max_f32 v46, v60, v61
    v_max_f32 v46, v46, v44
    v_sub_f32 v47, v44, v46
    v_exp_f32 v47, v47
    v_mov_b32 v44, v46
    v_sub_f32 v40, v40, v46
    v_sub_f32 v41, v41, v46
    v_sub_f32 v42, v42, v46
    v_sub_f32 v43, v43, v46
    v_exp_f32 v40, v40
    v_exp_f32 v41, v41
    v_exp_f32 v42, v42
    v_exp_f32 v43, v43
    v_mul_f32 v45, v45, v47
    v_mul_f32 v48, v48, v47
    v_mul_f32 v49, v49, v47
    v_mul_f32 v50, v50, v47
    v_mul_f32 v51, v51, v47
    v_mul_f32 v52, v52, v47
    v_mul_f32 v53, v53, v47
    v_mul_f32 v54, v54, v47
    v_mul_f32 v55, v55, v47
    v_mul_f32 v56, v56, v47
    v_mul_f32 v57, v57, v47
    v_mul_f32 v58, v58, v47
    v_mul_f32 v59, v59, v47
    v_add_f32 v45, v45, v40
    v_add_f32 v45, v45, v41
    v_add_f32 v45, v45, v42
    v_add_f32 v45, v45, v43
    v_lshlrev_b32 v60, 16, v88
    v_and_b32 v61, 0xffff0000, v88
    v_fmac_f32 v48, v40, v60
    v_fmac_f32 v49, v40, v61
    v_lshlrev_b32 v60, 16, v89
    v_and_b32 v61, 0xffff0000, v89
    v_fmac_f32 v50, v40, v60
    v_fmac_f32 v51, v40, v61
    v_lshlrev_b32 v60, 16, v90
    v_and_b32 v61, 0xffff0000, v90
    v_fmac_f32 v52, v40, v60
    v_fmac_f32 v53, v40, v61
    v_lshlrev_b32 v60, 16, v91
    v_and_b32 v61, 0xffff0000, v91
    v_fmac_f32 v54, v40, v60
    v_fmac_f32 v55, v40, v61
    v_lshlrev_b32 v60, 16, v92
    v_and_b32 v61, 0xffff0000, v92
    v_fmac_f32 v56, v40, v60
    v_fmac_f32 v57, v40, v61
    v_lshlrev_b32 v60, 16, v93
    v_and_b32 v61, 0xffff0000, v93
    v_fmac_f32 v58, v40, v60
    v_fmac_f32 v59, v40, v61
    v_lshlrev_b32 v60, 16, v94
    v_and_b32 v61, 0xffff0000, v94
    v_fmac_f32 v48, v41, v60
    v_fmac_f32 v49, v41, v61
    v_lshlrev_b32 v60, 16, v95
    v_and_b32 v61, 0xffff0000, v95
    v_fmac_f32 v50, v41, v60
    v_fmac_f32 v51, v41, v61
    v_lshlrev_b32 v60, 16, v96
    v_and_b32 v61, 0xffff0000, v96
    v_fmac_f32 v52, v41, v60
    v_fmac_f32 v53, v41, v61
    v_lshlrev_b32 v60, 16, v97
    v_and_b32 v61, 0xffff0000, v97
    v_fmac_f32 v54, v41, v60
    v_fmac_f32 v55, v41, v61
    v_lshlrev_b32 v60, 16, v98
    v_and_b32 v61, 0xffff0000, v98
    v_fmac_f32 v56, v41, v60
    v_fmac_f32 v57, v41, v61
    v_lshlrev_b32 v60, 16, v99
    v_and_b32 v61, 0xffff0000, v99
    v_fmac_f32 v58, v41, v60
    v_fmac_f32 v59, v41, v61
    v_lshlrev_b32 v60, 16, v100
    v_and_b32 v61, 0xffff0000, v100
    v_fmac_f32 v48, v42, v60
    v_fmac_f32 v49, v42, v61
    v_lshlrev_b32 v60, 16, v101
    v_and_b32 v61, 0xffff0000, v101
    v_fmac_f32 v50, v42, v60
    v_fmac_f32 v51, v42, v61
    v_lshlrev_b32 v60, 16, v102
    v_and_b32 v61, 0xffff0000, v102
    v_fmac_f32 v52, v42, v60
    v_fmac_f32 v53, v42, v61
    v_lshlrev_b32 v60, 16, v103
    v_and_b32 v61, 0xffff0000, v103
    v_fmac_f32 v54, v42, v60
    v_fmac_f32 v55, v42, v61
    v_lshlrev_b32 v60, 16, v104
    v_and_b32 v61, 0xffff0000, v104
    v_fmac_f32 v56, v42, v60
    v_fmac_f32 v57, v42, v61
    v_lshlrev_b32 v60, 16, v105
    v_and_b32 v61, 0xffff0000, v105
    v_fmac_f32 v58, v42, v60
    v_fmac_f32 v59, v42, v61
    v_lshlrev_b32 v60, 16, v106
    v_and_b32 v61, 0xffff0000, v106
    v_fmac_f32 v48, v43, v60
    v_fmac_f32 v49, v43, v61
    v_lshlrev_b32 v60, 16, v107
    v_and_b32 v61, 0xffff0000, v107
    v_fmac_f32 v50, v43, v60
    v_fmac_f32 v51, v43, v61
    v_lshlrev_b32 v60, 16, v108
    v_and_b32 v61, 0xffff0000, v108
    v_fmac_f32 v52, v43, v60
    v_fmac_f32 v53, v43, v61
    v_lshlrev_b32 v60, 16, v109
    v_and_b32 v61, 0xffff0000, v109
    v_fmac_f32 v54, v43, v60
    v_fmac_f32 v55, v43, v61
    v_lshlrev_b32 v60, 16, v110
    v_and_b32 v61, 0xffff0000, v110
    v_fmac_f32 v56, v43, v60
    v_fmac_f32 v57, v43, v61
    v_lshlrev_b32 v60, 16, v111
    v_and_b32 v61, 0xffff0000, v111
    v_fmac_f32 v58, v43, v60
    v_fmac_f32 v59, v43, v61
    s_mov_b32 s30, 294912
    buffer_load_dwordx4 v[64:67], v10, s[8:11], s30 offen offset:0 nt
    buffer_load_dwordx4 v[68:71], v10, s[8:11], s30 offen offset:64 nt
    buffer_load_dwordx4 v[72:75], v10, s[8:11], s30 offen offset:128 nt
    buffer_load_dwordx4 v[76:79], v10, s[8:11], s30 offen offset:192 nt
    buffer_load_dwordx4 v[80:83], v10, s[8:11], s30 offen offset:256 nt
    buffer_load_dwordx4 v[84:87], v10, s[8:11], s30 offen offset:320 nt
    buffer_load_dwordx4 v[88:91], v11, s[16:19], s30 offen offset:0 nt
    buffer_load_dwordx2 v[92:93], v12, s[16:19], s30 offen offset:0 nt
    buffer_load_dwordx4 v[94:97], v11, s[16:19], s30 offen offset:384 nt
    buffer_load_dwordx2 v[98:99], v12, s[16:19], s30 offen offset:384 nt
    buffer_load_dwordx4 v[100:103], v11, s[16:19], s30 offen offset:768 nt
    buffer_load_dwordx2 v[104:105], v12, s[16:19], s30 offen offset:768 nt
    buffer_load_dwordx4 v[106:109], v11, s[16:19], s30 offen offset:1152 nt
    buffer_load_dwordx2 v[110:111], v12, s[16:19], s30 offen offset:1152 nt
    s_waitcnt vmcnt(28)
    v_mov_b32 v40, 0
    v_mov_b32 v41, 0
    v_mov_b32 v42, 0
    v_mov_b32 v43, 0
    s_nop 1
    v_mfma_f32_16x16x32_bf16 v[40:43], v[112:115], v[16:19], v[40:43]
    v_mfma_f32_16x16x32_bf16 v[40:43], v[116:119], v[20:23], v[40:43]
    v_mfma_f32_16x16x32_bf16 v[40:43], v[120:123], v[24:27], v[40:43]
    v_mfma_f32_16x16x32_bf16 v[40:43], v[124:127], v[28:31], v[40:43]
    v_mfma_f32_16x16x32_bf16 v[40:43], v[128:131], v[32:35], v[40:43]
    v_mfma_f32_16x16x32_bf16 v[40:43], v[132:135], v[36:39], v[40:43]
    s_nop 9
    v_mul_f32 v40, s31, v40
    v_mul_f32 v41, s31, v41
    v_mul_f32 v42, s31, v42
    v_mul_f32 v43, s31, v43
    v_max3_f32 v46, v40, v41, v42
    v_max_f32 v46, v46, v43
    v_mov_b32 v60, v46
    v_mov_b32 v61, v46
    s_nop 1
    v_permlane32_swap_b32 v60, v61
    s_nop 1
    v_max_f32 v46, v60, v61
    v_mov_b32 v60, v46
    v_mov_b32 v61, v46
    s_nop 1
    v_permlane16_swap_b32 v60, v61
    s_nop 1
    v_max_f32 v46, v60, v61
    v_max_f32 v46, v46, v44
    v_sub_f32 v47, v44, v46
    v_exp_f32 v47, v47
    v_mov_b32 v44, v46
    v_sub_f32 v40, v40, v46
    v_sub_f32 v41, v41, v46
    v_sub_f32 v42, v42, v46
    v_sub_f32 v43, v43, v46
    v_exp_f32 v40, v40
    v_exp_f32 v41, v41
    v_exp_f32 v42, v42
    v_exp_f32 v43, v43
    v_mul_f32 v45, v45, v47
    v_mul_f32 v48, v48, v47
    v_mul_f32 v49, v49, v47
    v_mul_f32 v50, v50, v47
    v_mul_f32 v51, v51, v47
    v_mul_f32 v52, v52, v47
    v_mul_f32 v53, v53, v47
    v_mul_f32 v54, v54, v47
    v_mul_f32 v55, v55, v47
    v_mul_f32 v56, v56, v47
    v_mul_f32 v57, v57, v47
    v_mul_f32 v58, v58, v47
    v_mul_f32 v59, v59, v47
    v_add_f32 v45, v45, v40
    v_add_f32 v45, v45, v41
    v_add_f32 v45, v45, v42
    v_add_f32 v45, v45, v43
    v_lshlrev_b32 v60, 16, v136
    v_and_b32 v61, 0xffff0000, v136
    v_fmac_f32 v48, v40, v60
    v_fmac_f32 v49, v40, v61
    v_lshlrev_b32 v60, 16, v137
    v_and_b32 v61, 0xffff0000, v137
    v_fmac_f32 v50, v40, v60
    v_fmac_f32 v51, v40, v61
    v_lshlrev_b32 v60, 16, v138
    v_and_b32 v61, 0xffff0000, v138
    v_fmac_f32 v52, v40, v60
    v_fmac_f32 v53, v40, v61
    v_lshlrev_b32 v60, 16, v139
    v_and_b32 v61, 0xffff0000, v139
    v_fmac_f32 v54, v40, v60
    v_fmac_f32 v55, v40, v61
    v_lshlrev_b32 v60, 16, v140
    v_and_b32 v61, 0xffff0000, v140
    v_fmac_f32 v56, v40, v60
    v_fmac_f32 v57, v40, v61
    v_lshlrev_b32 v60, 16, v141
    v_and_b32 v61, 0xffff0000, v141
    v_fmac_f32 v58, v40, v60
    v_fmac_f32 v59, v40, v61
    v_lshlrev_b32 v60, 16, v142
    v_and_b32 v61, 0xffff0000, v142
    v_fmac_f32 v48, v41, v60
    v_fmac_f32 v49, v41, v61
    v_lshlrev_b32 v60, 16, v143
    v_and_b32 v61, 0xffff0000, v143
    v_fmac_f32 v50, v41, v60
    v_fmac_f32 v51, v41, v61
    v_lshlrev_b32 v60, 16, v144
    v_and_b32 v61, 0xffff0000, v144
    v_fmac_f32 v52, v41, v60
    v_fmac_f32 v53, v41, v61
    v_lshlrev_b32 v60, 16, v145
    v_and_b32 v61, 0xffff0000, v145
    v_fmac_f32 v54, v41, v60
    v_fmac_f32 v55, v41, v61
    v_lshlrev_b32 v60, 16, v146
    v_and_b32 v61, 0xffff0000, v146
    v_fmac_f32 v56, v41, v60
    v_fmac_f32 v57, v41, v61
    v_lshlrev_b32 v60, 16, v147
    v_and_b32 v61, 0xffff0000, v147
    v_fmac_f32 v58, v41, v60
    v_fmac_f32 v59, v41, v61
    v_lshlrev_b32 v60, 16, v148
    v_and_b32 v61, 0xffff0000, v148
    v_fmac_f32 v48, v42, v60
    v_fmac_f32 v49, v42, v61
    v_lshlrev_b32 v60, 16, v149
    v_and_b32 v61, 0xffff0000, v149
    v_fmac_f32 v50, v42, v60
    v_fmac_f32 v51, v42, v61
    v_lshlrev_b32 v60, 16, v150
    v_and_b32 v61, 0xffff0000, v150
    v_fmac_f32 v52, v42, v60
    v_fmac_f32 v53, v42, v61
    v_lshlrev_b32 v60, 16, v151
    v_and_b32 v61, 0xffff0000, v151
    v_fmac_f32 v54, v42, v60
    v_fmac_f32 v55, v42, v61
    v_lshlrev_b32 v60, 16, v152
    v_and_b32 v61, 0xffff0000, v152
    v_fmac_f32 v56, v42, v60
    v_fmac_f32 v57, v42, v61
    v_lshlrev_b32 v60, 16, v153
    v_and_b32 v61, 0xffff0000, v153
    v_fmac_f32 v58, v42, v60
    v_fmac_f32 v59, v42, v61
    v_lshlrev_b32 v60, 16, v154
    v_and_b32 v61, 0xffff0000, v154
    v_fmac_f32 v48, v43, v60
    v_fmac_f32 v49, v43, v61
    v_lshlrev_b32 v60, 16, v155
    v_and_b32 v61, 0xffff0000, v155
    v_fmac_f32 v50, v43, v60
    v_fmac_f32 v51, v43, v61
    v_lshlrev_b32 v60, 16, v156
    v_and_b32 v61, 0xffff0000, v156
    v_fmac_f32 v52, v43, v60
    v_fmac_f32 v53, v43, v61
    v_lshlrev_b32 v60, 16, v157
    v_and_b32 v61, 0xffff0000, v157
    v_fmac_f32 v54, v43, v60
    v_fmac_f32 v55, v43, v61
    v_lshlrev_b32 v60, 16, v158
    v_and_b32 v61, 0xffff0000, v158
    v_fmac_f32 v56, v43, v60
    v_fmac_f32 v57, v43, v61
    v_lshlrev_b32 v60, 16, v159
    v_and_b32 v61, 0xffff0000, v159
    v_fmac_f32 v58, v43, v60
    v_fmac_f32 v59, v43, v61
    s_mov_b32 s30, 319488
    buffer_load_dwordx4 v[112:115], v10, s[8:11], s30 offen offset:0 nt
    buffer_load_dwordx4 v[116:119], v10, s[8:11], s30 offen offset:64 nt
    buffer_load_dwordx4 v[120:123], v10, s[8:11], s30 offen offset:128 nt
    buffer_load_dwordx4 v[124:127], v10, s[8:11], s30 offen offset:192 nt
    buffer_load_dwordx4 v[128:131], v10, s[8:11], s30 offen offset:256 nt
    buffer_load_dwordx4 v[132:135], v10, s[8:11], s30 offen offset:320 nt
    buffer_load_dwordx4 v[136:139], v11, s[16:19], s30 offen offset:0 nt
    buffer_load_dwordx2 v[140:141], v12, s[16:19], s30 offen offset:0 nt
    buffer_load_dwordx4 v[142:145], v11, s[16:19], s30 offen offset:384 nt
    buffer_load_dwordx2 v[146:147], v12, s[16:19], s30 offen offset:384 nt
    buffer_load_dwordx4 v[148:151], v11, s[16:19], s30 offen offset:768 nt
    buffer_load_dwordx2 v[152:153], v12, s[16:19], s30 offen offset:768 nt
    buffer_load_dwordx4 v[154:157], v11, s[16:19], s30 offen offset:1152 nt
    buffer_load_dwordx2 v[158:159], v12, s[16:19], s30 offen offset:1152 nt
    s_waitcnt vmcnt(28)
    v_mov_b32 v40, 0
    v_mov_b32 v41, 0
    v_mov_b32 v42, 0
    v_mov_b32 v43, 0
    s_nop 1
    v_mfma_f32_16x16x32_bf16 v[40:43], v[160:163], v[16:19], v[40:43]
    v_mfma_f32_16x16x32_bf16 v[40:43], v[164:167], v[20:23], v[40:43]
    v_mfma_f32_16x16x32_bf16 v[40:43], v[168:171], v[24:27], v[40:43]
    v_mfma_f32_16x16x32_bf16 v[40:43], v[172:175], v[28:31], v[40:43]
    v_mfma_f32_16x16x32_bf16 v[40:43], v[176:179], v[32:35], v[40:43]
    v_mfma_f32_16x16x32_bf16 v[40:43], v[180:183], v[36:39], v[40:43]
    s_nop 9
    v_mul_f32 v40, s31, v40
    v_mul_f32 v41, s31, v41
    v_mul_f32 v42, s31, v42
    v_mul_f32 v43, s31, v43
    v_max3_f32 v46, v40, v41, v42
    v_max_f32 v46, v46, v43
    v_mov_b32 v60, v46
    v_mov_b32 v61, v46
    s_nop 1
    v_permlane32_swap_b32 v60, v61
    s_nop 1
    v_max_f32 v46, v60, v61
    v_mov_b32 v60, v46
    v_mov_b32 v61, v46
    s_nop 1
    v_permlane16_swap_b32 v60, v61
    s_nop 1
    v_max_f32 v46, v60, v61
    v_max_f32 v46, v46, v44
    v_sub_f32 v47, v44, v46
    v_exp_f32 v47, v47
    v_mov_b32 v44, v46
    v_sub_f32 v40, v40, v46
    v_sub_f32 v41, v41, v46
    v_sub_f32 v42, v42, v46
    v_sub_f32 v43, v43, v46
    v_exp_f32 v40, v40
    v_exp_f32 v41, v41
    v_exp_f32 v42, v42
    v_exp_f32 v43, v43
    v_mul_f32 v45, v45, v47
    v_mul_f32 v48, v48, v47
    v_mul_f32 v49, v49, v47
    v_mul_f32 v50, v50, v47
    v_mul_f32 v51, v51, v47
    v_mul_f32 v52, v52, v47
    v_mul_f32 v53, v53, v47
    v_mul_f32 v54, v54, v47
    v_mul_f32 v55, v55, v47
    v_mul_f32 v56, v56, v47
    v_mul_f32 v57, v57, v47
    v_mul_f32 v58, v58, v47
    v_mul_f32 v59, v59, v47
    v_add_f32 v45, v45, v40
    v_add_f32 v45, v45, v41
    v_add_f32 v45, v45, v42
    v_add_f32 v45, v45, v43
    v_lshlrev_b32 v60, 16, v184
    v_and_b32 v61, 0xffff0000, v184
    v_fmac_f32 v48, v40, v60
    v_fmac_f32 v49, v40, v61
    v_lshlrev_b32 v60, 16, v185
    v_and_b32 v61, 0xffff0000, v185
    v_fmac_f32 v50, v40, v60
    v_fmac_f32 v51, v40, v61
    v_lshlrev_b32 v60, 16, v186
    v_and_b32 v61, 0xffff0000, v186
    v_fmac_f32 v52, v40, v60
    v_fmac_f32 v53, v40, v61
    v_lshlrev_b32 v60, 16, v187
    v_and_b32 v61, 0xffff0000, v187
    v_fmac_f32 v54, v40, v60
    v_fmac_f32 v55, v40, v61
    v_lshlrev_b32 v60, 16, v188
    v_and_b32 v61, 0xffff0000, v188
    v_fmac_f32 v56, v40, v60
    v_fmac_f32 v57, v40, v61
    v_lshlrev_b32 v60, 16, v189
    v_and_b32 v61, 0xffff0000, v189
    v_fmac_f32 v58, v40, v60
    v_fmac_f32 v59, v40, v61
    v_lshlrev_b32 v60, 16, v190
    v_and_b32 v61, 0xffff0000, v190
    v_fmac_f32 v48, v41, v60
    v_fmac_f32 v49, v41, v61
    v_lshlrev_b32 v60, 16, v191
    v_and_b32 v61, 0xffff0000, v191
    v_fmac_f32 v50, v41, v60
    v_fmac_f32 v51, v41, v61
    v_lshlrev_b32 v60, 16, v192
    v_and_b32 v61, 0xffff0000, v192
    v_fmac_f32 v52, v41, v60
    v_fmac_f32 v53, v41, v61
    v_lshlrev_b32 v60, 16, v193
    v_and_b32 v61, 0xffff0000, v193
    v_fmac_f32 v54, v41, v60
    v_fmac_f32 v55, v41, v61
    v_lshlrev_b32 v60, 16, v194
    v_and_b32 v61, 0xffff0000, v194
    v_fmac_f32 v56, v41, v60
    v_fmac_f32 v57, v41, v61
    v_lshlrev_b32 v60, 16, v195
    v_and_b32 v61, 0xffff0000, v195
    v_fmac_f32 v58, v41, v60
    v_fmac_f32 v59, v41, v61
    v_lshlrev_b32 v60, 16, v196
    v_and_b32 v61, 0xffff0000, v196
    v_fmac_f32 v48, v42, v60
    v_fmac_f32 v49, v42, v61
    v_lshlrev_b32 v60, 16, v197
    v_and_b32 v61, 0xffff0000, v197
    v_fmac_f32 v50, v42, v60
    v_fmac_f32 v51, v42, v61
    v_lshlrev_b32 v60, 16, v198
    v_and_b32 v61, 0xffff0000, v198
    v_fmac_f32 v52, v42, v60
    v_fmac_f32 v53, v42, v61
    v_lshlrev_b32 v60, 16, v199
    v_and_b32 v61, 0xffff0000, v199
    v_fmac_f32 v54, v42, v60
    v_fmac_f32 v55, v42, v61
    v_lshlrev_b32 v60, 16, v200
    v_and_b32 v61, 0xffff0000, v200
    v_fmac_f32 v56, v42, v60
    v_fmac_f32 v57, v42, v61
    v_lshlrev_b32 v60, 16, v201
    v_and_b32 v61, 0xffff0000, v201
    v_fmac_f32 v58, v42, v60
    v_fmac_f32 v59, v42, v61
    v_lshlrev_b32 v60, 16, v202
    v_and_b32 v61, 0xffff0000, v202
    v_fmac_f32 v48, v43, v60
    v_fmac_f32 v49, v43, v61
    v_lshlrev_b32 v60, 16, v203
    v_and_b32 v61, 0xffff0000, v203
    v_fmac_f32 v50, v43, v60
    v_fmac_f32 v51, v43, v61
    v_lshlrev_b32 v60, 16, v204
    v_and_b32 v61, 0xffff0000, v204
    v_fmac_f32 v52, v43, v60
    v_fmac_f32 v53, v43, v61
    v_lshlrev_b32 v60, 16, v205
    v_and_b32 v61, 0xffff0000, v205
    v_fmac_f32 v54, v43, v60
    v_fmac_f32 v55, v43, v61
    v_lshlrev_b32 v60, 16, v206
    v_and_b32 v61, 0xffff0000, v206
    v_fmac_f32 v56, v43, v60
    v_fmac_f32 v57, v43, v61
    v_lshlrev_b32 v60, 16, v207
    v_and_b32 v61, 0xffff0000, v207
    v_fmac_f32 v58, v43, v60
    v_fmac_f32 v59, v43, v61
    s_mov_b32 s30, 344064
    buffer_load_dwordx4 v[160:163], v10, s[8:11], s30 offen offset:0 nt
    buffer_load_dwordx4 v[164:167], v10, s[8:11], s30 offen offset:64 nt
    buffer_load_dwordx4 v[168:171], v10, s[8:11], s30 offen offset:128 nt
    buffer_load_dwordx4 v[172:175], v10, s[8:11], s30 offen offset:192 nt
    buffer_load_dwordx4 v[176:179], v10, s[8:11], s30 offen offset:256 nt
    buffer_load_dwordx4 v[180:183], v10, s[8:11], s30 offen offset:320 nt
    buffer_load_dwordx4 v[184:187], v11, s[16:19], s30 offen offset:0 nt
    buffer_load_dwordx2 v[188:189], v12, s[16:19], s30 offen offset:0 nt
    buffer_load_dwordx4 v[190:193], v11, s[16:19], s30 offen offset:384 nt
    buffer_load_dwordx2 v[194:195], v12, s[16:19], s30 offen offset:384 nt
    buffer_load_dwordx4 v[196:199], v11, s[16:19], s30 offen offset:768 nt
    buffer_load_dwordx2 v[200:201], v12, s[16:19], s30 offen offset:768 nt
    buffer_load_dwordx4 v[202:205], v11, s[16:19], s30 offen offset:1152 nt
    buffer_load_dwordx2 v[206:207], v12, s[16:19], s30 offen offset:1152 nt
    s_waitcnt vmcnt(28)
    v_mov_b32 v40, 0
    v_mov_b32 v41, 0
    v_mov_b32 v42, 0
    v_mov_b32 v43, 0
    s_nop 1
    v_mfma_f32_16x16x32_bf16 v[40:43], v[64:67], v[16:19], v[40:43]
    v_mfma_f32_16x16x32_bf16 v[40:43], v[68:71], v[20:23], v[40:43]
    v_mfma_f32_16x16x32_bf16 v[40:43], v[72:75], v[24:27], v[40:43]
    v_mfma_f32_16x16x32_bf16 v[40:43], v[76:79], v[28:31], v[40:43]
    v_mfma_f32_16x16x32_bf16 v[40:43], v[80:83], v[32:35], v[40:43]
    v_mfma_f32_16x16x32_bf16 v[40:43], v[84:87], v[36:39], v[40:43]
    s_nop 9
    v_mul_f32 v40, s31, v40
    v_mul_f32 v41, s31, v41
    v_mul_f32 v42, s31, v42
    v_mul_f32 v43, s31, v43
    v_max3_f32 v46, v40, v41, v42
    v_max_f32 v46, v46, v43
    v_mov_b32 v60, v46
    v_mov_b32 v61, v46
    s_nop 1
    v_permlane32_swap_b32 v60, v61
    s_nop 1
    v_max_f32 v46, v60, v61
    v_mov_b32 v60, v46
    v_mov_b32 v61, v46
    s_nop 1
    v_permlane16_swap_b32 v60, v61
    s_nop 1
    v_max_f32 v46, v60, v61
    v_max_f32 v46, v46, v44
    v_sub_f32 v47, v44, v46
    v_exp_f32 v47, v47
    v_mov_b32 v44, v46
    v_sub_f32 v40, v40, v46
    v_sub_f32 v41, v41, v46
    v_sub_f32 v42, v42, v46
    v_sub_f32 v43, v43, v46
    v_exp_f32 v40, v40
    v_exp_f32 v41, v41
    v_exp_f32 v42, v42
    v_exp_f32 v43, v43
    v_mul_f32 v45, v45, v47
    v_mul_f32 v48, v48, v47
    v_mul_f32 v49, v49, v47
    v_mul_f32 v50, v50, v47
    v_mul_f32 v51, v51, v47
    v_mul_f32 v52, v52, v47
    v_mul_f32 v53, v53, v47
    v_mul_f32 v54, v54, v47
    v_mul_f32 v55, v55, v47
    v_mul_f32 v56, v56, v47
    v_mul_f32 v57, v57, v47
    v_mul_f32 v58, v58, v47
    v_mul_f32 v59, v59, v47
    v_add_f32 v45, v45, v40
    v_add_f32 v45, v45, v41
    v_add_f32 v45, v45, v42
    v_add_f32 v45, v45, v43
    v_lshlrev_b32 v60, 16, v88
    v_and_b32 v61, 0xffff0000, v88
    v_fmac_f32 v48, v40, v60
    v_fmac_f32 v49, v40, v61
    v_lshlrev_b32 v60, 16, v89
    v_and_b32 v61, 0xffff0000, v89
    v_fmac_f32 v50, v40, v60
    v_fmac_f32 v51, v40, v61
    v_lshlrev_b32 v60, 16, v90
    v_and_b32 v61, 0xffff0000, v90
    v_fmac_f32 v52, v40, v60
    v_fmac_f32 v53, v40, v61
    v_lshlrev_b32 v60, 16, v91
    v_and_b32 v61, 0xffff0000, v91
    v_fmac_f32 v54, v40, v60
    v_fmac_f32 v55, v40, v61
    v_lshlrev_b32 v60, 16, v92
    v_and_b32 v61, 0xffff0000, v92
    v_fmac_f32 v56, v40, v60
    v_fmac_f32 v57, v40, v61
    v_lshlrev_b32 v60, 16, v93
    v_and_b32 v61, 0xffff0000, v93
    v_fmac_f32 v58, v40, v60
    v_fmac_f32 v59, v40, v61
    v_lshlrev_b32 v60, 16, v94
    v_and_b32 v61, 0xffff0000, v94
    v_fmac_f32 v48, v41, v60
    v_fmac_f32 v49, v41, v61
    v_lshlrev_b32 v60, 16, v95
    v_and_b32 v61, 0xffff0000, v95
    v_fmac_f32 v50, v41, v60
    v_fmac_f32 v51, v41, v61
    v_lshlrev_b32 v60, 16, v96
    v_and_b32 v61, 0xffff0000, v96
    v_fmac_f32 v52, v41, v60
    v_fmac_f32 v53, v41, v61
    v_lshlrev_b32 v60, 16, v97
    v_and_b32 v61, 0xffff0000, v97
    v_fmac_f32 v54, v41, v60
    v_fmac_f32 v55, v41, v61
    v_lshlrev_b32 v60, 16, v98
    v_and_b32 v61, 0xffff0000, v98
    v_fmac_f32 v56, v41, v60
    v_fmac_f32 v57, v41, v61
    v_lshlrev_b32 v60, 16, v99
    v_and_b32 v61, 0xffff0000, v99
    v_fmac_f32 v58, v41, v60
    v_fmac_f32 v59, v41, v61
    v_lshlrev_b32 v60, 16, v100
    v_and_b32 v61, 0xffff0000, v100
    v_fmac_f32 v48, v42, v60
    v_fmac_f32 v49, v42, v61
    v_lshlrev_b32 v60, 16, v101
    v_and_b32 v61, 0xffff0000, v101
    v_fmac_f32 v50, v42, v60
    v_fmac_f32 v51, v42, v61
    v_lshlrev_b32 v60, 16, v102
    v_and_b32 v61, 0xffff0000, v102
    v_fmac_f32 v52, v42, v60
    v_fmac_f32 v53, v42, v61
    v_lshlrev_b32 v60, 16, v103
    v_and_b32 v61, 0xffff0000, v103
    v_fmac_f32 v54, v42, v60
    v_fmac_f32 v55, v42, v61
    v_lshlrev_b32 v60, 16, v104
    v_and_b32 v61, 0xffff0000, v104
    v_fmac_f32 v56, v42, v60
    v_fmac_f32 v57, v42, v61
    v_lshlrev_b32 v60, 16, v105
    v_and_b32 v61, 0xffff0000, v105
    v_fmac_f32 v58, v42, v60
    v_fmac_f32 v59, v42, v61
    v_lshlrev_b32 v60, 16, v106
    v_and_b32 v61, 0xffff0000, v106
    v_fmac_f32 v48, v43, v60
    v_fmac_f32 v49, v43, v61
    v_lshlrev_b32 v60, 16, v107
    v_and_b32 v61, 0xffff0000, v107
    v_fmac_f32 v50, v43, v60
    v_fmac_f32 v51, v43, v61
    v_lshlrev_b32 v60, 16, v108
    v_and_b32 v61, 0xffff0000, v108
    v_fmac_f32 v52, v43, v60
    v_fmac_f32 v53, v43, v61
    v_lshlrev_b32 v60, 16, v109
    v_and_b32 v61, 0xffff0000, v109
    v_fmac_f32 v54, v43, v60
    v_fmac_f32 v55, v43, v61
    v_lshlrev_b32 v60, 16, v110
    v_and_b32 v61, 0xffff0000, v110
    v_fmac_f32 v56, v43, v60
    v_fmac_f32 v57, v43, v61
    v_lshlrev_b32 v60, 16, v111
    v_and_b32 v61, 0xffff0000, v111
    v_fmac_f32 v58, v43, v60
    v_fmac_f32 v59, v43, v61
    s_mov_b32 s30, 368640
    buffer_load_dwordx4 v[64:67], v10, s[8:11], s30 offen offset:0 nt
    buffer_load_dwordx4 v[68:71], v10, s[8:11], s30 offen offset:64 nt
    buffer_load_dwordx4 v[72:75], v10, s[8:11], s30 offen offset:128 nt
    buffer_load_dwordx4 v[76:79], v10, s[8:11], s30 offen offset:192 nt
    buffer_load_dwordx4 v[80:83], v10, s[8:11], s30 offen offset:256 nt
    buffer_load_dwordx4 v[84:87], v10, s[8:11], s30 offen offset:320 nt
    buffer_load_dwordx4 v[88:91], v11, s[16:19], s30 offen offset:0 nt
    buffer_load_dwordx2 v[92:93], v12, s[16:19], s30 offen offset:0 nt
    buffer_load_dwordx4 v[94:97], v11, s[16:19], s30 offen offset:384 nt
    buffer_load_dwordx2 v[98:99], v12, s[16:19], s30 offen offset:384 nt
    buffer_load_dwordx4 v[100:103], v11, s[16:19], s30 offen offset:768 nt
    buffer_load_dwordx2 v[104:105], v12, s[16:19], s30 offen offset:768 nt
    buffer_load_dwordx4 v[106:109], v11, s[16:19], s30 offen offset:1152 nt
    buffer_load_dwordx2 v[110:111], v12, s[16:19], s30 offen offset:1152 nt
    s_waitcnt vmcnt(28)
    v_mov_b32 v40, 0
    v_mov_b32 v41, 0
    v_mov_b32 v42, 0
    v_mov_b32 v43, 0
    s_nop 1
    v_mfma_f32_16x16x32_bf16 v[40:43], v[112:115], v[16:19], v[40:43]
    v_mfma_f32_16x16x32_bf16 v[40:43], v[116:119], v[20:23], v[40:43]
    v_mfma_f32_16x16x32_bf16 v[40:43], v[120:123], v[24:27], v[40:43]
    v_mfma_f32_16x16x32_bf16 v[40:43], v[124:127], v[28:31], v[40:43]
    v_mfma_f32_16x16x32_bf16 v[40:43], v[128:131], v[32:35], v[40:43]
    v_mfma_f32_16x16x32_bf16 v[40:43], v[132:135], v[36:39], v[40:43]
    s_nop 9
    v_mul_f32 v40, s31, v40
    v_mul_f32 v41, s31, v41
    v_mul_f32 v42, s31, v42
    v_mul_f32 v43, s31, v43
    v_max3_f32 v46, v40, v41, v42
    v_max_f32 v46, v46, v43
    v_mov_b32 v60, v46
    v_mov_b32 v61, v46
    s_nop 1
    v_permlane32_swap_b32 v60, v61
    s_nop 1
    v_max_f32 v46, v60, v61
    v_mov_b32 v60, v46
    v_mov_b32 v61, v46
    s_nop 1
    v_permlane16_swap_b32 v60, v61
    s_nop 1
    v_max_f32 v46, v60, v61
    v_max_f32 v46, v46, v44
    v_sub_f32 v47, v44, v46
    v_exp_f32 v47, v47
    v_mov_b32 v44, v46
    v_sub_f32 v40, v40, v46
    v_sub_f32 v41, v41, v46
    v_sub_f32 v42, v42, v46
    v_sub_f32 v43, v43, v46
    v_exp_f32 v40, v40
    v_exp_f32 v41, v41
    v_exp_f32 v42, v42
    v_exp_f32 v43, v43
    v_mul_f32 v45, v45, v47
    v_mul_f32 v48, v48, v47
    v_mul_f32 v49, v49, v47
    v_mul_f32 v50, v50, v47
    v_mul_f32 v51, v51, v47
    v_mul_f32 v52, v52, v47
    v_mul_f32 v53, v53, v47
    v_mul_f32 v54, v54, v47
    v_mul_f32 v55, v55, v47
    v_mul_f32 v56, v56, v47
    v_mul_f32 v57, v57, v47
    v_mul_f32 v58, v58, v47
    v_mul_f32 v59, v59, v47
    v_add_f32 v45, v45, v40
    v_add_f32 v45, v45, v41
    v_add_f32 v45, v45, v42
    v_add_f32 v45, v45, v43
    v_lshlrev_b32 v60, 16, v136
    v_and_b32 v61, 0xffff0000, v136
    v_fmac_f32 v48, v40, v60
    v_fmac_f32 v49, v40, v61
    v_lshlrev_b32 v60, 16, v137
    v_and_b32 v61, 0xffff0000, v137
    v_fmac_f32 v50, v40, v60
    v_fmac_f32 v51, v40, v61
    v_lshlrev_b32 v60, 16, v138
    v_and_b32 v61, 0xffff0000, v138
    v_fmac_f32 v52, v40, v60
    v_fmac_f32 v53, v40, v61
    v_lshlrev_b32 v60, 16, v139
    v_and_b32 v61, 0xffff0000, v139
    v_fmac_f32 v54, v40, v60
    v_fmac_f32 v55, v40, v61
    v_lshlrev_b32 v60, 16, v140
    v_and_b32 v61, 0xffff0000, v140
    v_fmac_f32 v56, v40, v60
    v_fmac_f32 v57, v40, v61
    v_lshlrev_b32 v60, 16, v141
    v_and_b32 v61, 0xffff0000, v141
    v_fmac_f32 v58, v40, v60
    v_fmac_f32 v59, v40, v61
    v_lshlrev_b32 v60, 16, v142
    v_and_b32 v61, 0xffff0000, v142
    v_fmac_f32 v48, v41, v60
    v_fmac_f32 v49, v41, v61
    v_lshlrev_b32 v60, 16, v143
    v_and_b32 v61, 0xffff0000, v143
    v_fmac_f32 v50, v41, v60
    v_fmac_f32 v51, v41, v61
    v_lshlrev_b32 v60, 16, v144
    v_and_b32 v61, 0xffff0000, v144
    v_fmac_f32 v52, v41, v60
    v_fmac_f32 v53, v41, v61
    v_lshlrev_b32 v60, 16, v145
    v_and_b32 v61, 0xffff0000, v145
    v_fmac_f32 v54, v41, v60
    v_fmac_f32 v55, v41, v61
    v_lshlrev_b32 v60, 16, v146
    v_and_b32 v61, 0xffff0000, v146
    v_fmac_f32 v56, v41, v60
    v_fmac_f32 v57, v41, v61
    v_lshlrev_b32 v60, 16, v147
    v_and_b32 v61, 0xffff0000, v147
    v_fmac_f32 v58, v41, v60
    v_fmac_f32 v59, v41, v61
    v_lshlrev_b32 v60, 16, v148
    v_and_b32 v61, 0xffff0000, v148
    v_fmac_f32 v48, v42, v60
    v_fmac_f32 v49, v42, v61
    v_lshlrev_b32 v60, 16, v149
    v_and_b32 v61, 0xffff0000, v149
    v_fmac_f32 v50, v42, v60
    v_fmac_f32 v51, v42, v61
    v_lshlrev_b32 v60, 16, v150
    v_and_b32 v61, 0xffff0000, v150
    v_fmac_f32 v52, v42, v60
    v_fmac_f32 v53, v42, v61
    v_lshlrev_b32 v60, 16, v151
    v_and_b32 v61, 0xffff0000, v151
    v_fmac_f32 v54, v42, v60
    v_fmac_f32 v55, v42, v61
    v_lshlrev_b32 v60, 16, v152
    v_and_b32 v61, 0xffff0000, v152
    v_fmac_f32 v56, v42, v60
    v_fmac_f32 v57, v42, v61
    v_lshlrev_b32 v60, 16, v153
    v_and_b32 v61, 0xffff0000, v153
    v_fmac_f32 v58, v42, v60
    v_fmac_f32 v59, v42, v61
    v_lshlrev_b32 v60, 16, v154
    v_and_b32 v61, 0xffff0000, v154
    v_fmac_f32 v48, v43, v60
    v_fmac_f32 v49, v43, v61
    v_lshlrev_b32 v60, 16, v155
    v_and_b32 v61, 0xffff0000, v155
    v_fmac_f32 v50, v43, v60
    v_fmac_f32 v51, v43, v61
    v_lshlrev_b32 v60, 16, v156
    v_and_b32 v61, 0xffff0000, v156
    v_fmac_f32 v52, v43, v60
    v_fmac_f32 v53, v43, v61
    v_lshlrev_b32 v60, 16, v157
    v_and_b32 v61, 0xffff0000, v157
    v_fmac_f32 v54, v43, v60
    v_fmac_f32 v55, v43, v61
    v_lshlrev_b32 v60, 16, v158
    v_and_b32 v61, 0xffff0000, v158
    v_fmac_f32 v56, v43, v60
    v_fmac_f32 v57, v43, v61
    v_lshlrev_b32 v60, 16, v159
    v_and_b32 v61, 0xffff0000, v159
    v_fmac_f32 v58, v43, v60
    v_fmac_f32 v59, v43, v61
    s_waitcnt vmcnt(14)
    v_mov_b32 v40, 0
    v_mov_b32 v41, 0
    v_mov_b32 v42, 0
    v_mov_b32 v43, 0
    s_nop 1
    v_mfma_f32_16x16x32_bf16 v[40:43], v[160:163], v[16:19], v[40:43]
    v_mfma_f32_16x16x32_bf16 v[40:43], v[164:167], v[20:23], v[40:43]
    v_mfma_f32_16x16x32_bf16 v[40:43], v[168:171], v[24:27], v[40:43]
    v_mfma_f32_16x16x32_bf16 v[40:43], v[172:175], v[28:31], v[40:43]
    v_mfma_f32_16x16x32_bf16 v[40:43], v[176:179], v[32:35], v[40:43]
    v_mfma_f32_16x16x32_bf16 v[40:43], v[180:183], v[36:39], v[40:43]
    s_nop 9
    v_mul_f32 v40, s31, v40
    v_mul_f32 v41, s31, v41
    v_mul_f32 v42, s31, v42
    v_mul_f32 v43, s31, v43
    v_max3_f32 v46, v40, v41, v42
    v_max_f32 v46, v46, v43
    v_mov_b32 v60, v46
    v_mov_b32 v61, v46
    s_nop 1
    v_permlane32_swap_b32 v60, v61
    s_nop 1
    v_max_f32 v46, v60, v61
    v_mov_b32 v60, v46
    v_mov_b32 v61, v46
    s_nop 1
    v_permlane16_swap_b32 v60, v61
    s_nop 1
    v_max_f32 v46, v60, v61
    v_max_f32 v46, v46, v44
    v_sub_f32 v47, v44, v46
    v_exp_f32 v47, v47
    v_mov_b32 v44, v46
    v_sub_f32 v40, v40, v46
    v_sub_f32 v41, v41, v46
    v_sub_f32 v42, v42, v46
    v_sub_f32 v43, v43, v46
    v_exp_f32 v40, v40
    v_exp_f32 v41, v41
    v_exp_f32 v42, v42
    v_exp_f32 v43, v43
    v_mul_f32 v45, v45, v47
    v_mul_f32 v48, v48, v47
    v_mul_f32 v49, v49, v47
    v_mul_f32 v50, v50, v47
    v_mul_f32 v51, v51, v47
    v_mul_f32 v52, v52, v47
    v_mul_f32 v53, v53, v47
    v_mul_f32 v54, v54, v47
    v_mul_f32 v55, v55, v47
    v_mul_f32 v56, v56, v47
    v_mul_f32 v57, v57, v47
    v_mul_f32 v58, v58, v47
    v_mul_f32 v59, v59, v47
    v_add_f32 v45, v45, v40
    v_add_f32 v45, v45, v41
    v_add_f32 v45, v45, v42
    v_add_f32 v45, v45, v43
    v_lshlrev_b32 v60, 16, v184
    v_and_b32 v61, 0xffff0000, v184
    v_fmac_f32 v48, v40, v60
    v_fmac_f32 v49, v40, v61
    v_lshlrev_b32 v60, 16, v185
    v_and_b32 v61, 0xffff0000, v185
    v_fmac_f32 v50, v40, v60
    v_fmac_f32 v51, v40, v61
    v_lshlrev_b32 v60, 16, v186
    v_and_b32 v61, 0xffff0000, v186
    v_fmac_f32 v52, v40, v60
    v_fmac_f32 v53, v40, v61
    v_lshlrev_b32 v60, 16, v187
    v_and_b32 v61, 0xffff0000, v187
    v_fmac_f32 v54, v40, v60
    v_fmac_f32 v55, v40, v61
    v_lshlrev_b32 v60, 16, v188
    v_and_b32 v61, 0xffff0000, v188
    v_fmac_f32 v56, v40, v60
    v_fmac_f32 v57, v40, v61
    v_lshlrev_b32 v60, 16, v189
    v_and_b32 v61, 0xffff0000, v189
    v_fmac_f32 v58, v40, v60
    v_fmac_f32 v59, v40, v61
    v_lshlrev_b32 v60, 16, v190
    v_and_b32 v61, 0xffff0000, v190
    v_fmac_f32 v48, v41, v60
    v_fmac_f32 v49, v41, v61
    v_lshlrev_b32 v60, 16, v191
    v_and_b32 v61, 0xffff0000, v191
    v_fmac_f32 v50, v41, v60
    v_fmac_f32 v51, v41, v61
    v_lshlrev_b32 v60, 16, v192
    v_and_b32 v61, 0xffff0000, v192
    v_fmac_f32 v52, v41, v60
    v_fmac_f32 v53, v41, v61
    v_lshlrev_b32 v60, 16, v193
    v_and_b32 v61, 0xffff0000, v193
    v_fmac_f32 v54, v41, v60
    v_fmac_f32 v55, v41, v61
    v_lshlrev_b32 v60, 16, v194
    v_and_b32 v61, 0xffff0000, v194
    v_fmac_f32 v56, v41, v60
    v_fmac_f32 v57, v41, v61
    v_lshlrev_b32 v60, 16, v195
    v_and_b32 v61, 0xffff0000, v195
    v_fmac_f32 v58, v41, v60
    v_fmac_f32 v59, v41, v61
    v_lshlrev_b32 v60, 16, v196
    v_and_b32 v61, 0xffff0000, v196
    v_fmac_f32 v48, v42, v60
    v_fmac_f32 v49, v42, v61
    v_lshlrev_b32 v60, 16, v197
    v_and_b32 v61, 0xffff0000, v197
    v_fmac_f32 v50, v42, v60
    v_fmac_f32 v51, v42, v61
    v_lshlrev_b32 v60, 16, v198
    v_and_b32 v61, 0xffff0000, v198
    v_fmac_f32 v52, v42, v60
    v_fmac_f32 v53, v42, v61
    v_lshlrev_b32 v60, 16, v199
    v_and_b32 v61, 0xffff0000, v199
    v_fmac_f32 v54, v42, v60
    v_fmac_f32 v55, v42, v61
    v_lshlrev_b32 v60, 16, v200
    v_and_b32 v61, 0xffff0000, v200
    v_fmac_f32 v56, v42, v60
    v_fmac_f32 v57, v42, v61
    v_lshlrev_b32 v60, 16, v201
    v_and_b32 v61, 0xffff0000, v201
    v_fmac_f32 v58, v42, v60
    v_fmac_f32 v59, v42, v61
    v_lshlrev_b32 v60, 16, v202
    v_and_b32 v61, 0xffff0000, v202
    v_fmac_f32 v48, v43, v60
    v_fmac_f32 v49, v43, v61
    v_lshlrev_b32 v60, 16, v203
    v_and_b32 v61, 0xffff0000, v203
    v_fmac_f32 v50, v43, v60
    v_fmac_f32 v51, v43, v61
    v_lshlrev_b32 v60, 16, v204
    v_and_b32 v61, 0xffff0000, v204
    v_fmac_f32 v52, v43, v60
    v_fmac_f32 v53, v43, v61
    v_lshlrev_b32 v60, 16, v205
    v_and_b32 v61, 0xffff0000, v205
    v_fmac_f32 v54, v43, v60
    v_fmac_f32 v55, v43, v61
    v_lshlrev_b32 v60, 16, v206
    v_and_b32 v61, 0xffff0000, v206
    v_fmac_f32 v56, v43, v60
    v_fmac_f32 v57, v43, v61
    v_lshlrev_b32 v60, 16, v207
    v_and_b32 v61, 0xffff0000, v207
    v_fmac_f32 v58, v43, v60
    v_fmac_f32 v59, v43, v61
    s_waitcnt vmcnt(0)
    v_mov_b32 v40, 0
    v_mov_b32 v41, 0
    v_mov_b32 v42, 0
    v_mov_b32 v43, 0
    s_nop 1
    v_mfma_f32_16x16x32_bf16 v[40:43], v[64:67], v[16:19], v[40:43]
    v_mfma_f32_16x16x32_bf16 v[40:43], v[68:71], v[20:23], v[40:43]
    v_mfma_f32_16x16x32_bf16 v[40:43], v[72:75], v[24:27], v[40:43]
    v_mfma_f32_16x16x32_bf16 v[40:43], v[76:79], v[28:31], v[40:43]
    v_mfma_f32_16x16x32_bf16 v[40:43], v[80:83], v[32:35], v[40:43]
    v_mfma_f32_16x16x32_bf16 v[40:43], v[84:87], v[36:39], v[40:43]
    s_nop 9
    v_mul_f32 v40, s31, v40
    v_mul_f32 v41, s31, v41
    v_mul_f32 v42, s31, v42
    v_mul_f32 v43, s31, v43
    v_max3_f32 v46, v40, v41, v42
    v_max_f32 v46, v46, v43
    v_mov_b32 v60, v46
    v_mov_b32 v61, v46
    s_nop 1
    v_permlane32_swap_b32 v60, v61
    s_nop 1
    v_max_f32 v46, v60, v61
    v_mov_b32 v60, v46
    v_mov_b32 v61, v46
    s_nop 1
    v_permlane16_swap_b32 v60, v61
    s_nop 1
    v_max_f32 v46, v60, v61
    v_max_f32 v46, v46, v44
    v_sub_f32 v47, v44, v46
    v_exp_f32 v47, v47
    v_mov_b32 v44, v46
    v_sub_f32 v40, v40, v46
    v_sub_f32 v41, v41, v46
    v_sub_f32 v42, v42, v46
    v_sub_f32 v43, v43, v46
    v_exp_f32 v40, v40
    v_exp_f32 v41, v41
    v_exp_f32 v42, v42
    v_exp_f32 v43, v43
    v_mul_f32 v45, v45, v47
    v_mul_f32 v48, v48, v47
    v_mul_f32 v49, v49, v47
    v_mul_f32 v50, v50, v47
    v_mul_f32 v51, v51, v47
    v_mul_f32 v52, v52, v47
    v_mul_f32 v53, v53, v47
    v_mul_f32 v54, v54, v47
    v_mul_f32 v55, v55, v47
    v_mul_f32 v56, v56, v47
    v_mul_f32 v57, v57, v47
    v_mul_f32 v58, v58, v47
    v_mul_f32 v59, v59, v47
    v_add_f32 v45, v45, v40
    v_add_f32 v45, v45, v41
    v_add_f32 v45, v45, v42
    v_add_f32 v45, v45, v43
    v_lshlrev_b32 v60, 16, v88
    v_and_b32 v61, 0xffff0000, v88
    v_fmac_f32 v48, v40, v60
    v_fmac_f32 v49, v40, v61
    v_lshlrev_b32 v60, 16, v89
    v_and_b32 v61, 0xffff0000, v89
    v_fmac_f32 v50, v40, v60
    v_fmac_f32 v51, v40, v61
    v_lshlrev_b32 v60, 16, v90
    v_and_b32 v61, 0xffff0000, v90
    v_fmac_f32 v52, v40, v60
    v_fmac_f32 v53, v40, v61
    v_lshlrev_b32 v60, 16, v91
    v_and_b32 v61, 0xffff0000, v91
    v_fmac_f32 v54, v40, v60
    v_fmac_f32 v55, v40, v61
    v_lshlrev_b32 v60, 16, v92
    v_and_b32 v61, 0xffff0000, v92
    v_fmac_f32 v56, v40, v60
    v_fmac_f32 v57, v40, v61
    v_lshlrev_b32 v60, 16, v93
    v_and_b32 v61, 0xffff0000, v93
    v_fmac_f32 v58, v40, v60
    v_fmac_f32 v59, v40, v61
    v_lshlrev_b32 v60, 16, v94
    v_and_b32 v61, 0xffff0000, v94
    v_fmac_f32 v48, v41, v60
    v_fmac_f32 v49, v41, v61
    v_lshlrev_b32 v60, 16, v95
    v_and_b32 v61, 0xffff0000, v95
    v_fmac_f32 v50, v41, v60
    v_fmac_f32 v51, v41, v61
    v_lshlrev_b32 v60, 16, v96
    v_and_b32 v61, 0xffff0000, v96
    v_fmac_f32 v52, v41, v60
    v_fmac_f32 v53, v41, v61
    v_lshlrev_b32 v60, 16, v97
    v_and_b32 v61, 0xffff0000, v97
    v_fmac_f32 v54, v41, v60
    v_fmac_f32 v55, v41, v61
    v_lshlrev_b32 v60, 16, v98
    v_and_b32 v61, 0xffff0000, v98
    v_fmac_f32 v56, v41, v60
    v_fmac_f32 v57, v41, v61
    v_lshlrev_b32 v60, 16, v99
    v_and_b32 v61, 0xffff0000, v99
    v_fmac_f32 v58, v41, v60
    v_fmac_f32 v59, v41, v61
    v_lshlrev_b32 v60, 16, v100
    v_and_b32 v61, 0xffff0000, v100
    v_fmac_f32 v48, v42, v60
    v_fmac_f32 v49, v42, v61
    v_lshlrev_b32 v60, 16, v101
    v_and_b32 v61, 0xffff0000, v101
    v_fmac_f32 v50, v42, v60
    v_fmac_f32 v51, v42, v61
    v_lshlrev_b32 v60, 16, v102
    v_and_b32 v61, 0xffff0000, v102
    v_fmac_f32 v52, v42, v60
    v_fmac_f32 v53, v42, v61
    v_lshlrev_b32 v60, 16, v103
    v_and_b32 v61, 0xffff0000, v103
    v_fmac_f32 v54, v42, v60
    v_fmac_f32 v55, v42, v61
    v_lshlrev_b32 v60, 16, v104
    v_and_b32 v61, 0xffff0000, v104
    v_fmac_f32 v56, v42, v60
    v_fmac_f32 v57, v42, v61
    v_lshlrev_b32 v60, 16, v105
    v_and_b32 v61, 0xffff0000, v105
    v_fmac_f32 v58, v42, v60
    v_fmac_f32 v59, v42, v61
    v_lshlrev_b32 v60, 16, v106
    v_and_b32 v61, 0xffff0000, v106
    v_fmac_f32 v48, v43, v60
    v_fmac_f32 v49, v43, v61
    v_lshlrev_b32 v60, 16, v107
    v_and_b32 v61, 0xffff0000, v107
    v_fmac_f32 v50, v43, v60
    v_fmac_f32 v51, v43, v61
    v_lshlrev_b32 v60, 16, v108
    v_and_b32 v61, 0xffff0000, v108
    v_fmac_f32 v52, v43, v60
    v_fmac_f32 v53, v43, v61
    v_lshlrev_b32 v60, 16, v109
    v_and_b32 v61, 0xffff0000, v109
    v_fmac_f32 v54, v43, v60
    v_fmac_f32 v55, v43, v61
    v_lshlrev_b32 v60, 16, v110
    v_and_b32 v61, 0xffff0000, v110
    v_fmac_f32 v56, v43, v60
    v_fmac_f32 v57, v43, v61
    v_lshlrev_b32 v60, 16, v111
    v_and_b32 v61, 0xffff0000, v111
    v_fmac_f32 v58, v43, v60
    v_fmac_f32 v59, v43, v61
    v_mov_b32 v60, v45
    v_mov_b32 v61, v45
    s_nop 1
    v_permlane32_swap_b32 v60, v61
    s_nop 1
    v_add_f32 v45, v60, v61
    v_mov_b32 v60, v45
    v_mov_b32 v61, v45
    s_nop 1
    v_permlane16_swap_b32 v60, v61
    s_nop 1
    v_add_f32 v45, v60, v61
    v_mov_b32 v60, v48
    v_mov_b32 v61, v48
    s_nop 1
    v_permlane32_swap_b32 v60, v61
    s_nop 1
    v_add_f32 v48, v60, v61
    v_mov_b32 v60, v48
    v_mov_b32 v61, v48
    s_nop 1
    v_permlane16_swap_b32 v60, v61
    s_nop 1
    v_add_f32 v48, v60, v61
    v_mov_b32 v60, v49
    v_mov_b32 v61, v49
    s_nop 1
    v_permlane32_swap_b32 v60, v61
    s_nop 1
    v_add_f32 v49, v60, v61
    v_mov_b32 v60, v49
    v_mov_b32 v61, v49
    s_nop 1
    v_permlane16_swap_b32 v60, v61
    s_nop 1
    v_add_f32 v49, v60, v61
    v_mov_b32 v60, v50
    v_mov_b32 v61, v50
    s_nop 1
    v_permlane32_swap_b32 v60, v61
    s_nop 1
    v_add_f32 v50, v60, v61
    v_mov_b32 v60, v50
    v_mov_b32 v61, v50
    s_nop 1
    v_permlane16_swap_b32 v60, v61
    s_nop 1
    v_add_f32 v50, v60, v61
    v_mov_b32 v60, v51
    v_mov_b32 v61, v51
    s_nop 1
    v_permlane32_swap_b32 v60, v61
    s_nop 1
    v_add_f32 v51, v60, v61
    v_mov_b32 v60, v51
    v_mov_b32 v61, v51
    s_nop 1
    v_permlane16_swap_b32 v60, v61
    s_nop 1
    v_add_f32 v51, v60, v61
    v_mov_b32 v60, v52
    v_mov_b32 v61, v52
    s_nop 1
    v_permlane32_swap_b32 v60, v61
    s_nop 1
    v_add_f32 v52, v60, v61
    v_mov_b32 v60, v52
    v_mov_b32 v61, v52
    s_nop 1
    v_permlane16_swap_b32 v60, v61
    s_nop 1
    v_add_f32 v52, v60, v61
    v_mov_b32 v60, v53
    v_mov_b32 v61, v53
    s_nop 1
    v_permlane32_swap_b32 v60, v61
    s_nop 1
    v_add_f32 v53, v60, v61
    v_mov_b32 v60, v53
    v_mov_b32 v61, v53
    s_nop 1
    v_permlane16_swap_b32 v60, v61
    s_nop 1
    v_add_f32 v53, v60, v61
    v_mov_b32 v60, v54
    v_mov_b32 v61, v54
    s_nop 1
    v_permlane32_swap_b32 v60, v61
    s_nop 1
    v_add_f32 v54, v60, v61
    v_mov_b32 v60, v54
    v_mov_b32 v61, v54
    s_nop 1
    v_permlane16_swap_b32 v60, v61
    s_nop 1
    v_add_f32 v54, v60, v61
    v_mov_b32 v60, v55
    v_mov_b32 v61, v55
    s_nop 1
    v_permlane32_swap_b32 v60, v61
    s_nop 1
    v_add_f32 v55, v60, v61
    v_mov_b32 v60, v55
    v_mov_b32 v61, v55
    s_nop 1
    v_permlane16_swap_b32 v60, v61
    s_nop 1
    v_add_f32 v55, v60, v61
    v_mov_b32 v60, v56
    v_mov_b32 v61, v56
    s_nop 1
    v_permlane32_swap_b32 v60, v61
    s_nop 1
    v_add_f32 v56, v60, v61
    v_mov_b32 v60, v56
    v_mov_b32 v61, v56
    s_nop 1
    v_permlane16_swap_b32 v60, v61
    s_nop 1
    v_add_f32 v56, v60, v61
    v_mov_b32 v60, v57
    v_mov_b32 v61, v57
    s_nop 1
    v_permlane32_swap_b32 v60, v61
    s_nop 1
    v_add_f32 v57, v60, v61
    v_mov_b32 v60, v57
    v_mov_b32 v61, v57
    s_nop 1
    v_permlane16_swap_b32 v60, v61
    s_nop 1
    v_add_f32 v57, v60, v61
    v_mov_b32 v60, v58
    v_mov_b32 v61, v58
    s_nop 1
    v_permlane32_swap_b32 v60, v61
    s_nop 1
    v_add_f32 v58, v60, v61
    v_mov_b32 v60, v58
    v_mov_b32 v61, v58
    s_nop 1
    v_permlane16_swap_b32 v60, v61
    s_nop 1
    v_add_f32 v58, v60, v61
    v_mov_b32 v60, v59
    v_mov_b32 v61, v59
    s_nop 1
    v_permlane32_swap_b32 v60, v61
    s_nop 1
    v_add_f32 v59, v60, v61
    v_mov_b32 v60, v59
    v_mov_b32 v61, v59
    s_nop 1
    v_permlane16_swap_b32 v60, v61
    s_nop 1
    v_add_f32 v59, v60, v61
    s_mul_i32 s24, s20, 800
    v_lshlrev_b32 v5, 5, v3
    v_add_u32 v5, s24, v5
    v_lshlrev_b32 v6, 4, v3
    v_add_u32 v6, s24, v6
    v_mov_b32 v7, s24
    v_cmp_gt_u32 vcc, 16, v2
    s_and_saveexec_b64 s[26:27], vcc
    ds_write_b128 v5, v[48:51]
    ds_write_b128 v5, v[52:55] offset:16
    ds_write_b128 v6, v[56:59] offset:512
    ds_write_b64 v7, v[44:45] offset:768
    s_mov_b64 exec, s[26:27]
    s_waitcnt lgkmcnt(0)
    s_barrier
    v_mov_b32 v7, 0
    v_lshlrev_b32 v5, 2, v0
    ds_read_b64 v[16:17], v7 offset:768
    ds_read_b64 v[18:19], v7 offset:1568
    ds_read_b64 v[20:21], v7 offset:2368
    ds_read_b64 v[22:23], v7 offset:3168
    ds_read_b32 v24, v5 offset:0
    ds_read_b32 v25, v5 offset:800
    ds_read_b32 v26, v5 offset:1600
    ds_read_b32 v27, v5 offset:2400
    s_waitcnt lgkmcnt(0)
    v_max3_f32 v30, v16, v18, v20
    v_max_f32 v30, v30, v22
    v_mov_b32 v31, 0
    v_mov_b32 v32, 0
    v_sub_f32 v33, v16, v30
    v_exp_f32 v33, v33
    s_nop 0
    v_fmac_f32 v31, v33, v17
    v_fmac_f32 v32, v33, v24
    v_sub_f32 v33, v18, v30
    v_exp_f32 v33, v33
    s_nop 0
    v_fmac_f32 v31, v33, v19
    v_fmac_f32 v32, v33, v25
    v_sub_f32 v33, v20, v30
    v_exp_f32 v33, v33
    s_nop 0
    v_fmac_f32 v31, v33, v21
    v_fmac_f32 v32, v33, v26
    v_sub_f32 v33, v22, v30
    v_exp_f32 v33, v33
    s_nop 0
    v_fmac_f32 v31, v33, v23
    v_fmac_f32 v32, v33, v27
    v_cmp_eq_u32 vcc, 192, v0
    s_nop 1
    v_cndmask_b32 v32, v32, v30, vcc
    v_cmp_eq_u32 vcc, 193, v0
    s_nop 1
    v_cndmask_b32 v32, v32, v31, vcc
    s_mul_i32 s24, s21, 784
    s_add_u32 s24, s24, 131072
    v_add_u32 v5, s24, v5
    v_cmp_gt_u32 vcc, 194, v0
    s_and_saveexec_b64 s[26:27], vcc
    buffer_store_dword v32, v5, s[12:15], 0 offen
    s_endpgm
K3_B:
    s_load_dwordx2 s[8:9], s[0:1], 48
    s_mov_b32 s10, 12582912
    s_mov_b32 s11, 0x00020000
    s_lshr_b32 s21, s20, 1
    s_and_b32 s22, s20, 1
    s_lshl_b32 s23, s22, 4
    v_add_u32 v5, s23, v3
    s_mov_b32 s24, 3072
    v_mul_lo_u32 v6, v5, s24
    v_lshlrev_b32 v7, 5, v4
    v_add3_u32 v6, v6, v7, 0
    v_add_u32 v6, 32768, v6
    s_waitcnt lgkmcnt(0)
    buffer_load_dwordx4 v[16:19], v6, s[12:15], 0 offen offset:0
    buffer_load_dwordx4 v[20:23], v6, s[12:15], 0 offen offset:16
    buffer_load_dwordx4 v[24:27], v6, s[12:15], 0 offen offset:128
    buffer_load_dwordx4 v[28:31], v6, s[12:15], 0 offen offset:144
    buffer_load_dwordx4 v[32:35], v6, s[12:15], 0 offen offset:256
    buffer_load_dwordx4 v[36:39], v6, s[12:15], 0 offen offset:272
    buffer_load_dwordx4 v[40:43], v6, s[12:15], 0 offen offset:384
    buffer_load_dwordx4 v[44:47], v6, s[12:15], 0 offen offset:400
    buffer_load_dwordx4 v[48:51], v6, s[12:15], 0 offen offset:512
    buffer_load_dwordx4 v[52:55], v6, s[12:15], 0 offen offset:528
    buffer_load_dwordx4 v[56:59], v6, s[12:15], 0 offen offset:640
    buffer_load_dwordx4 v[60:63], v6, s[12:15], 0 offen offset:656
    s_waitcnt vmcnt(0)
    v_cvt_pk_bf16_f32 v64, v16, v17
    v_cvt_pk_bf16_f32 v65, v18, v19
    v_cvt_pk_bf16_f32 v66, v20, v21
    v_cvt_pk_bf16_f32 v67, v22, v23
    v_cvt_pk_bf16_f32 v68, v24, v25
    v_cvt_pk_bf16_f32 v69, v26, v27
    v_cvt_pk_bf16_f32 v70, v28, v29
    v_cvt_pk_bf16_f32 v71, v30, v31
    v_cvt_pk_bf16_f32 v72, v32, v33
    v_cvt_pk_bf16_f32 v73, v34, v35
    v_cvt_pk_bf16_f32 v74, v36, v37
    v_cvt_pk_bf16_f32 v75, v38, v39
    v_cvt_pk_bf16_f32 v76, v40, v41
    v_cvt_pk_bf16_f32 v77, v42, v43
    v_cvt_pk_bf16_f32 v78, v44, v45
    v_cvt_pk_bf16_f32 v79, v46, v47
    v_cvt_pk_bf16_f32 v80, v48, v49
    v_cvt_pk_bf16_f32 v81, v50, v51
    v_cvt_pk_bf16_f32 v82, v52, v53
    v_cvt_pk_bf16_f32 v83, v54, v55
    v_cvt_pk_bf16_f32 v84, v56, v57
    v_cvt_pk_bf16_f32 v85, v58, v59
    v_cvt_pk_bf16_f32 v86, v60, v61
    v_cvt_pk_bf16_f32 v87, v62, v63
    buffer_load_dwordx4 v[16:19], v6, s[12:15], 0 offen offset:768
    buffer_load_dwordx4 v[20:23], v6, s[12:15], 0 offen offset:784
    buffer_load_dwordx4 v[24:27], v6, s[12:15], 0 offen offset:896
    buffer_load_dwordx4 v[28:31], v6, s[12:15], 0 offen offset:912
    buffer_load_dwordx4 v[32:35], v6, s[12:15], 0 offen offset:1024
    buffer_load_dwordx4 v[36:39], v6, s[12:15], 0 offen offset:1040
    buffer_load_dwordx4 v[40:43], v6, s[12:15], 0 offen offset:1152
    buffer_load_dwordx4 v[44:47], v6, s[12:15], 0 offen offset:1168
    buffer_load_dwordx4 v[48:51], v6, s[12:15], 0 offen offset:1280
    buffer_load_dwordx4 v[52:55], v6, s[12:15], 0 offen offset:1296
    buffer_load_dwordx4 v[56:59], v6, s[12:15], 0 offen offset:1408
    buffer_load_dwordx4 v[60:63], v6, s[12:15], 0 offen offset:1424
    s_waitcnt vmcnt(0)
    v_cvt_pk_bf16_f32 v88, v16, v17
    v_cvt_pk_bf16_f32 v89, v18, v19
    v_cvt_pk_bf16_f32 v90, v20, v21
    v_cvt_pk_bf16_f32 v91, v22, v23
    v_cvt_pk_bf16_f32 v92, v24, v25
    v_cvt_pk_bf16_f32 v93, v26, v27
    v_cvt_pk_bf16_f32 v94, v28, v29
    v_cvt_pk_bf16_f32 v95, v30, v31
    v_cvt_pk_bf16_f32 v96, v32, v33
    v_cvt_pk_bf16_f32 v97, v34, v35
    v_cvt_pk_bf16_f32 v98, v36, v37
    v_cvt_pk_bf16_f32 v99, v38, v39
    v_cvt_pk_bf16_f32 v100, v40, v41
    v_cvt_pk_bf16_f32 v101, v42, v43
    v_cvt_pk_bf16_f32 v102, v44, v45
    v_cvt_pk_bf16_f32 v103, v46, v47
    v_cvt_pk_bf16_f32 v104, v48, v49
    v_cvt_pk_bf16_f32 v105, v50, v51
    v_cvt_pk_bf16_f32 v106, v52, v53
    v_cvt_pk_bf16_f32 v107, v54, v55
    v_cvt_pk_bf16_f32 v108, v56, v57
    v_cvt_pk_bf16_f32 v109, v58, v59
    v_cvt_pk_bf16_f32 v110, v60, v61
    v_cvt_pk_bf16_f32 v111, v62, v63
    buffer_load_dwordx4 v[16:19], v6, s[12:15], 0 offen offset:1536
    buffer_load_dwordx4 v[20:23], v6, s[12:15], 0 offen offset:1552
    buffer_load_dwordx4 v[24:27], v6, s[12:15], 0 offen offset:1664
    buffer_load_dwordx4 v[28:31], v6, s[12:15], 0 offen offset:1680
    buffer_load_dwordx4 v[32:35], v6, s[12:15], 0 offen offset:1792
    buffer_load_dwordx4 v[36:39], v6, s[12:15], 0 offen offset:1808
    buffer_load_dwordx4 v[40:43], v6, s[12:15], 0 offen offset:1920
    buffer_load_dwordx4 v[44:47], v6, s[12:15], 0 offen offset:1936
    buffer_load_dwordx4 v[48:51], v6, s[12:15], 0 offen offset:2048
    buffer_load_dwordx4 v[52:55], v6, s[12:15], 0 offen offset:2064
    buffer_load_dwordx4 v[56:59], v6, s[12:15], 0 offen offset:2176
    buffer_load_dwordx4 v[60:63], v6, s[12:15], 0 offen offset:2192
    s_waitcnt vmcnt(0)
    v_cvt_pk_bf16_f32 v112, v16, v17
    v_cvt_pk_bf16_f32 v113, v18, v19
    v_cvt_pk_bf16_f32 v114, v20, v21
    v_cvt_pk_bf16_f32 v115, v22, v23
    v_cvt_pk_bf16_f32 v116, v24, v25
    v_cvt_pk_bf16_f32 v117, v26, v27
    v_cvt_pk_bf16_f32 v118, v28, v29
    v_cvt_pk_bf16_f32 v119, v30, v31
    v_cvt_pk_bf16_f32 v120, v32, v33
    v_cvt_pk_bf16_f32 v121, v34, v35
    v_cvt_pk_bf16_f32 v122, v36, v37
    v_cvt_pk_bf16_f32 v123, v38, v39
    v_cvt_pk_bf16_f32 v124, v40, v41
    v_cvt_pk_bf16_f32 v125, v42, v43
    v_cvt_pk_bf16_f32 v126, v44, v45
    v_cvt_pk_bf16_f32 v127, v46, v47
    v_cvt_pk_bf16_f32 v128, v48, v49
    v_cvt_pk_bf16_f32 v129, v50, v51
    v_cvt_pk_bf16_f32 v130, v52, v53
    v_cvt_pk_bf16_f32 v131, v54, v55
    v_cvt_pk_bf16_f32 v132, v56, v57
    v_cvt_pk_bf16_f32 v133, v58, v59
    v_cvt_pk_bf16_f32 v134, v60, v61
    v_cvt_pk_bf16_f32 v135, v62, v63
    buffer_load_dwordx4 v[16:19], v6, s[12:15], 0 offen offset:2304
    buffer_load_dwordx4 v[20:23], v6, s[12:15], 0 offen offset:2320
    buffer_load_dwordx4 v[24:27], v6, s[12:15], 0 offen offset:2432
    buffer_load_dwordx4 v[28:31], v6, s[12:15], 0 offen offset:2448
    buffer_load_dwordx4 v[32:35], v6, s[12:15], 0 offen offset:2560
    buffer_load_dwordx4 v[36:39], v6, s[12:15], 0 offen offset:2576
    buffer_load_dwordx4 v[40:43], v6, s[12:15], 0 offen offset:2688
    buffer_load_dwordx4 v[44:47], v6, s[12:15], 0 offen offset:2704
    buffer_load_dwordx4 v[48:51], v6, s[12:15], 0 offen offset:2816
    buffer_load_dwordx4 v[52:55], v6, s[12:15], 0 offen offset:2832
    buffer_load_dwordx4 v[56:59], v6, s[12:15], 0 offen offset:2944
    buffer_load_dwordx4 v[60:63], v6, s[12:15], 0 offen offset:2960
    s_waitcnt vmcnt(0)
    v_cvt_pk_bf16_f32 v136, v16, v17
    v_cvt_pk_bf16_f32 v137, v18, v19
    v_cvt_pk_bf16_f32 v138, v20, v21
    v_cvt_pk_bf16_f32 v139, v22, v23
    v_cvt_pk_bf16_f32 v140, v24, v25
    v_cvt_pk_bf16_f32 v141, v26, v27
    v_cvt_pk_bf16_f32 v142, v28, v29
    v_cvt_pk_bf16_f32 v143, v30, v31
    v_cvt_pk_bf16_f32 v144, v32, v33
    v_cvt_pk_bf16_f32 v145, v34, v35
    v_cvt_pk_bf16_f32 v146, v36, v37
    v_cvt_pk_bf16_f32 v147, v38, v39
    v_cvt_pk_bf16_f32 v148, v40, v41
    v_cvt_pk_bf16_f32 v149, v42, v43
    v_cvt_pk_bf16_f32 v150, v44, v45
    v_cvt_pk_bf16_f32 v151, v46, v47
    v_cvt_pk_bf16_f32 v152, v48, v49
    v_cvt_pk_bf16_f32 v153, v50, v51
    v_cvt_pk_bf16_f32 v154, v52, v53
    v_cvt_pk_bf16_f32 v155, v54, v55
    v_cvt_pk_bf16_f32 v156, v56, v57
    v_cvt_pk_bf16_f32 v157, v58, v59
    v_cvt_pk_bf16_f32 v158, v60, v61
    v_cvt_pk_bf16_f32 v159, v62, v63
    v_mov_b32 v160, 0
    v_mov_b32 v161, 0
    v_mov_b32 v162, 0
    v_mov_b32 v163, 0
    v_mov_b32 v164, 0
    v_mov_b32 v165, 0
    v_mov_b32 v166, 0
    v_mov_b32 v167, 0
    v_mov_b32 v168, 0
    v_mov_b32 v169, 0
    v_mov_b32 v170, 0
    v_mov_b32 v171, 0
    v_mov_b32 v172, 0
    v_mov_b32 v173, 0
    v_mov_b32 v174, 0
    v_mov_b32 v175, 0
    v_mov_b32 v176, 0
    v_mov_b32 v177, 0
    v_mov_b32 v178, 0
    v_mov_b32 v179, 0
    v_mov_b32 v180, 0
    v_mov_b32 v181, 0
    v_mov_b32 v182, 0
    v_mov_b32 v183, 0
    v_mov_b32 v184, 0
    v_mov_b32 v185, 0
    v_mov_b32 v186, 0
    v_mov_b32 v187, 0
    v_mov_b32 v188, 0
    v_mov_b32 v189, 0
    v_mov_b32 v190, 0
    v_mov_b32 v191, 0
    v_mov_b32 v192, 0
    v_mov_b32 v193, 0
    v_mov_b32 v194, 0
    v_mov_b32 v195, 0
    v_mov_b32 v196, 0
    v_mov_b32 v197, 0
    v_mov_b32 v198, 0
    v_mov_b32 v199, 0
    v_mov_b32 v200, 0
    v_mov_b32 v201, 0
    v_mov_b32 v202, 0
    v_mov_b32 v203, 0
    v_mov_b32 v204, 0
    v_mov_b32 v205, 0
    v_mov_b32 v206, 0
    v_mov_b32 v207, 0
    v_mov_b32 v208, 0
    v_mov_b32 v209, 0
    v_mov_b32 v210, 0
    v_mov_b32 v211, 0
    v_mov_b32 v212, 0
    v_mov_b32 v213, 0
    v_mov_b32 v214, 0
    v_mov_b32 v215, 0
    v_mov_b32 v216, 0
    v_mov_b32 v217, 0
    v_mov_b32 v218, 0
    v_mov_b32 v219, 0
    v_mov_b32 v220, 0
    v_mov_b32 v221, 0
    v_mov_b32 v222, 0
    v_mov_b32 v223, 0
    v_mov_b32 v224, 0
    v_mov_b32 v225, 0
    v_mov_b32 v226, 0
    v_mov_b32 v227, 0
    v_mov_b32 v228, 0
    v_mov_b32 v229, 0
    v_mov_b32 v230, 0
    v_mov_b32 v231, 0
    v_mov_b32 v232, 0
    v_mov_b32 v233, 0
    v_mov_b32 v234, 0
    v_mov_b32 v235, 0
    v_mov_b32 v236, 0
    v_mov_b32 v237, 0
    v_mov_b32 v238, 0
    v_mov_b32 v239, 0
    v_mov_b32 v240, 0
    v_mov_b32 v241, 0
    v_mov_b32 v242, 0
    v_mov_b32 v243, 0
    v_mov_b32 v244, 0
    v_mov_b32 v245, 0
    v_mov_b32 v246, 0
    v_mov_b32 v247, 0
    v_mov_b32 v248, 0
    v_mov_b32 v249, 0
    v_mov_b32 v250, 0
    v_mov_b32 v251, 0
    v_mov_b32 v252, 0
    v_mov_b32 v253, 0
    v_mov_b32 v254, 0
    v_mov_b32 v255, 0
    v_mov_b32 v8, 0xf149f2ca
    v_mov_b32 v9, 0
    v_lshrrev_b32 v10, 3, v0
    v_and_b32 v11, 7, v0
    v_lshlrev_b32 v11, 4, v11
    s_mov_b32 s24, 1536
    v_mul_lo_u32 v12, v10, s24
    v_add_u32 v12, v12, v11
    s_mul_i32 s24, s2, 393216
    v_add_u32 v12, s24, v12
    s_mov_b32 s24, 1552
    v_mul_lo_u32 v13, v10, s24
    v_add_u32 v13, v13, v11
    s_lshl_b32 s23, s21, 4
    v_add_u32 v14, s23, v3
    v_mul_lo_u32 v14, v14, s24
    v_lshlrev_b32 v7, 4, v4
    v_add_u32 v14, v14, v7
    v_lshrrev_b32 v15, 2, v3
    v_lshl_add_u32 v15, v4, 3, v15
    v_mul_lo_u32 v15, v15, s24
    v_and_b32 v7, 3, v2
    v_lshlrev_b32 v7, 3, v7
    s_mul_i32 s25, s20, 384
    v_add3_u32 v15, v15, v7, s25
    s_mov_b32 s30, 0
    s_mov_b32 s33, 0
K3_BLOOP:
    buffer_load_dwordx4 v[16:19], v12, s[8:11], s30 offen offset:0
    buffer_load_dwordx4 v[20:23], v12, s[8:11], s30 offen offset:128
    buffer_load_dwordx4 v[24:27], v12, s[8:11], s30 offen offset:256
    buffer_load_dwordx4 v[28:31], v12, s[8:11], s30 offen offset:384
    buffer_load_dwordx4 v[32:35], v12, s[8:11], s30 offen offset:512
    buffer_load_dwordx4 v[36:39], v12, s[8:11], s30 offen offset:640
    buffer_load_dwordx4 v[40:43], v12, s[8:11], s30 offen offset:768
    buffer_load_dwordx4 v[44:47], v12, s[8:11], s30 offen offset:896
    buffer_load_dwordx4 v[48:51], v12, s[8:11], s30 offen offset:1024
    buffer_load_dwordx4 v[52:55], v12, s[8:11], s30 offen offset:1152
    buffer_load_dwordx4 v[56:59], v12, s[8:11], s30 offen offset:1280
    buffer_load_dwordx4 v[60:63], v12, s[8:11], s30 offen offset:1408
    s_waitcnt vmcnt(11)
    ds_write_b128 v13, v[16:19] offset:0
    s_waitcnt vmcnt(10)
    ds_write_b128 v13, v[20:23] offset:128
    s_waitcnt vmcnt(9)
    ds_write_b128 v13, v[24:27] offset:256
    s_waitcnt vmcnt(8)
    ds_write_b128 v13, v[28:31] offset:384
    s_waitcnt vmcnt(7)
    ds_write_b128 v13, v[32:35] offset:512
    s_waitcnt vmcnt(6)
    ds_write_b128 v13, v[36:39] offset:640
    s_waitcnt vmcnt(5)
    ds_write_b128 v13, v[40:43] offset:768
    s_waitcnt vmcnt(4)
    ds_write_b128 v13, v[44:47] offset:896
    s_waitcnt vmcnt(3)
    ds_write_b128 v13, v[48:51] offset:1024
    s_waitcnt vmcnt(2)
    ds_write_b128 v13, v[52:55] offset:1152
    s_waitcnt vmcnt(1)
    ds_write_b128 v13, v[56:59] offset:1280
    s_waitcnt vmcnt(0)
    ds_write_b128 v13, v[60:63] offset:1408
    s_waitcnt lgkmcnt(0)
    s_barrier
    v_mov_b32 v40, 0
    v_mov_b32 v41, 0
    v_mov_b32 v42, 0
    v_mov_b32 v43, 0
    ds_read_b128 v[16:19], v14 offset:0
    ds_read_b128 v[20:23], v14 offset:64
    ds_read_b128 v[24:27], v14 offset:128
    ds_read_b128 v[28:31], v14 offset:192
    s_waitcnt lgkmcnt(0)
    v_mfma_f32_16x16x32_bf16 v[40:43], v[16:19], v[64:67], v[40:43]
    v_mfma_f32_16x16x32_bf16 v[40:43], v[20:23], v[68:71], v[40:43]
    v_mfma_f32_16x16x32_bf16 v[40:43], v[24:27], v[72:75], v[40:43]
    v_mfma_f32_16x16x32_bf16 v[40:43], v[28:31], v[76:79], v[40:43]
    ds_read_b128 v[16:19], v14 offset:256
    ds_read_b128 v[20:23], v14 offset:320
    ds_read_b128 v[24:27], v14 offset:384
    ds_read_b128 v[28:31], v14 offset:448
    s_waitcnt lgkmcnt(0)
    v_mfma_f32_16x16x32_bf16 v[40:43], v[16:19], v[80:83], v[40:43]
    v_mfma_f32_16x16x32_bf16 v[40:43], v[20:23], v[84:87], v[40:43]
    v_mfma_f32_16x16x32_bf16 v[40:43], v[24:27], v[88:91], v[40:43]
    v_mfma_f32_16x16x32_bf16 v[40:43], v[28:31], v[92:95], v[40:43]
    ds_read_b128 v[16:19], v14 offset:512
    ds_read_b128 v[20:23], v14 offset:576
    ds_read_b128 v[24:27], v14 offset:640
    ds_read_b128 v[28:31], v14 offset:704
    s_waitcnt lgkmcnt(0)
    v_mfma_f32_16x16x32_bf16 v[40:43], v[16:19], v[96:99], v[40:43]
    v_mfma_f32_16x16x32_bf16 v[40:43], v[20:23], v[100:103], v[40:43]
    v_mfma_f32_16x16x32_bf16 v[40:43], v[24:27], v[104:107], v[40:43]
    v_mfma_f32_16x16x32_bf16 v[40:43], v[28:31], v[108:111], v[40:43]
    ds_read_b128 v[16:19], v14 offset:768
    ds_read_b128 v[20:23], v14 offset:832
    ds_read_b128 v[24:27], v14 offset:896
    ds_read_b128 v[28:31], v14 offset:960
    s_waitcnt lgkmcnt(0)
    v_mfma_f32_16x16x32_bf16 v[40:43], v[16:19], v[112:115], v[40:43]
    v_mfma_f32_16x16x32_bf16 v[40:43], v[20:23], v[116:119], v[40:43]
    v_mfma_f32_16x16x32_bf16 v[40:43], v[24:27], v[120:123], v[40:43]
    v_mfma_f32_16x16x32_bf16 v[40:43], v[28:31], v[124:127], v[40:43]
    ds_read_b128 v[16:19], v14 offset:1024
    ds_read_b128 v[20:23], v14 offset:1088
    ds_read_b128 v[24:27], v14 offset:1152
    ds_read_b128 v[28:31], v14 offset:1216
    s_waitcnt lgkmcnt(0)
    v_mfma_f32_16x16x32_bf16 v[40:43], v[16:19], v[128:131], v[40:43]
    v_mfma_f32_16x16x32_bf16 v[40:43], v[20:23], v[132:135], v[40:43]
    v_mfma_f32_16x16x32_bf16 v[40:43], v[24:27], v[136:139], v[40:43]
    v_mfma_f32_16x16x32_bf16 v[40:43], v[28:31], v[140:143], v[40:43]
    ds_read_b128 v[16:19], v14 offset:1280
    ds_read_b128 v[20:23], v14 offset:1344
    ds_read_b128 v[24:27], v14 offset:1408
    ds_read_b128 v[28:31], v14 offset:1472
    s_waitcnt lgkmcnt(0)
    v_mfma_f32_16x16x32_bf16 v[40:43], v[16:19], v[144:147], v[40:43]
    v_mfma_f32_16x16x32_bf16 v[40:43], v[20:23], v[148:151], v[40:43]
    v_mfma_f32_16x16x32_bf16 v[40:43], v[24:27], v[152:155], v[40:43]
    v_mfma_f32_16x16x32_bf16 v[40:43], v[28:31], v[156:159], v[40:43]
    s_nop 9
    v_max3_f32 v46, v40, v41, v42
    v_max_f32 v46, v46, v43
    v_mov_b32 v60, v46
    v_mov_b32 v61, v46
    s_nop 1
    v_permlane32_swap_b32 v60, v61
    s_nop 1
    v_max_f32 v46, v60, v61
    v_mov_b32 v60, v46
    v_mov_b32 v61, v46
    s_nop 1
    v_permlane16_swap_b32 v60, v61
    s_nop 1
    v_max_f32 v46, v60, v61
    v_lshlrev_b32 v7, 2, v5
    s_lshl_b32 s23, s21, 7
    v_add_u32 v47, s23, v7
    s_xor_b32 s23, s23, 128
    v_add_u32 v48, s23, v7
    ds_write_b32 v47, v46 offset:52224
    s_waitcnt lgkmcnt(0)
    s_barrier
    ds_read_b32 v49, v48 offset:52224
    s_waitcnt lgkmcnt(0)
    v_max3_f32 v46, v46, v49, v8
    v_sub_f32 v47, v8, v46
    v_exp_f32 v47, v47
    v_mov_b32 v8, v46
    v_sub_f32 v40, v40, v46
    v_sub_f32 v41, v41, v46
    v_sub_f32 v42, v42, v46
    v_sub_f32 v43, v43, v46
    v_exp_f32 v40, v40
    v_exp_f32 v41, v41
    v_exp_f32 v42, v42
    v_exp_f32 v43, v43
    v_mul_f32 v9, v9, v47
    v_add_f32 v9, v9, v40
    v_add_f32 v9, v9, v41
    v_add_f32 v9, v9, v42
    v_add_f32 v9, v9, v43
    v_cvt_pk_bf16_f32 v50, v40, v41
    v_cvt_pk_bf16_f32 v51, v42, v43
    s_mov_b32 s24, 80
    v_mul_lo_u32 v52, v5, s24
    v_lshlrev_b32 v53, 3, v4
    s_lshl_b32 s23, s21, 5
    v_add3_u32 v52, v52, v53, s23
    ds_write_b64 v52, v[50:51] offset:49664
    ds_write_b32 v7, v47 offset:52480
    s_waitcnt lgkmcnt(0)
    s_barrier
    v_mul_lo_u32 v52, v3, s24
    v_lshlrev_b32 v53, 4, v4
    v_add_u32 v52, v52, v53
    ds_read_b128 v[40:43], v52 offset:49664
    ds_read_b128 v[44:47], v52 offset:50944
    ds_read_b128 v[48:51], v53 offset:52480
    ds_read_b128 v[56:59], v53 offset:52544
    s_waitcnt lgkmcnt(0)
    v_mul_f32 v160, v160, v48
    v_mul_f32 v161, v161, v49
    v_mul_f32 v162, v162, v50
    v_mul_f32 v163, v163, v51
    v_mul_f32 v164, v164, v56
    v_mul_f32 v165, v165, v57
    v_mul_f32 v166, v166, v58
    v_mul_f32 v167, v167, v59
    v_mul_f32 v168, v168, v48
    v_mul_f32 v169, v169, v49
    v_mul_f32 v170, v170, v50
    v_mul_f32 v171, v171, v51
    v_mul_f32 v172, v172, v56
    v_mul_f32 v173, v173, v57
    v_mul_f32 v174, v174, v58
    v_mul_f32 v175, v175, v59
    v_mul_f32 v176, v176, v48
    v_mul_f32 v177, v177, v49
    v_mul_f32 v178, v178, v50
    v_mul_f32 v179, v179, v51
    v_mul_f32 v180, v180, v56
    v_mul_f32 v181, v181, v57
    v_mul_f32 v182, v182, v58
    v_mul_f32 v183, v183, v59
    v_mul_f32 v184, v184, v48
    v_mul_f32 v185, v185, v49
    v_mul_f32 v186, v186, v50
    v_mul_f32 v187, v187, v51
    v_mul_f32 v188, v188, v56
    v_mul_f32 v189, v189, v57
    v_mul_f32 v190, v190, v58
    v_mul_f32 v191, v191, v59
    v_mul_f32 v192, v192, v48
    v_mul_f32 v193, v193, v49
    v_mul_f32 v194, v194, v50
    v_mul_f32 v195, v195, v51
    v_mul_f32 v196, v196, v56
    v_mul_f32 v197, v197, v57
    v_mul_f32 v198, v198, v58
    v_mul_f32 v199, v199, v59
    v_mul_f32 v200, v200, v48
    v_mul_f32 v201, v201, v49
    v_mul_f32 v202, v202, v50
    v_mul_f32 v203, v203, v51
    v_mul_f32 v204, v204, v56
    v_mul_f32 v205, v205, v57
    v_mul_f32 v206, v206, v58
    v_mul_f32 v207, v207, v59
    v_mul_f32 v208, v208, v48
    v_mul_f32 v209, v209, v49
    v_mul_f32 v210, v210, v50
    v_mul_f32 v211, v211, v51
    v_mul_f32 v212, v212, v56
    v_mul_f32 v213, v213, v57
    v_mul_f32 v214, v214, v58
    v_mul_f32 v215, v215, v59
    v_mul_f32 v216, v216, v48
    v_mul_f32 v217, v217, v49
    v_mul_f32 v218, v218, v50
    v_mul_f32 v219, v219, v51
    v_mul_f32 v220, v220, v56
    v_mul_f32 v221, v221, v57
    v_mul_f32 v222, v222, v58
    v_mul_f32 v223, v223, v59
    v_mul_f32 v224, v224, v48
    v_mul_f32 v225, v225, v49
    v_mul_f32 v226, v226, v50
    v_mul_f32 v227, v227, v51
    v_mul_f32 v228, v228, v56
    v_mul_f32 v229, v229, v57
    v_mul_f32 v230, v230, v58
    v_mul_f32 v231, v231, v59
    v_mul_f32 v232, v232, v48
    v_mul_f32 v233, v233, v49
    v_mul_f32 v234, v234, v50
    v_mul_f32 v235, v235, v51
    v_mul_f32 v236, v236, v56
    v_mul_f32 v237, v237, v57
    v_mul_f32 v238, v238, v58
    v_mul_f32 v239, v239, v59
    v_mul_f32 v240, v240, v48
    v_mul_f32 v241, v241, v49
    v_mul_f32 v242, v242, v50
    v_mul_f32 v243, v243, v51
    v_mul_f32 v244, v244, v56
    v_mul_f32 v245, v245, v57
    v_mul_f32 v246, v246, v58
    v_mul_f32 v247, v247, v59
    v_mul_f32 v248, v248, v48
    v_mul_f32 v249, v249, v49
    v_mul_f32 v250, v250, v50
    v_mul_f32 v251, v251, v51
    v_mul_f32 v252, v252, v56
    v_mul_f32 v253, v253, v57
    v_mul_f32 v254, v254, v58
    v_mul_f32 v255, v255, v59
    ds_read_b64_tr_b16 v[16:17], v15 offset:0
    ds_read_b64_tr_b16 v[18:19], v15 offset:6208
    ds_read_b64_tr_b16 v[20:21], v15 offset:32
    ds_read_b64_tr_b16 v[22:23], v15 offset:6240
    ds_read_b64_tr_b16 v[24:25], v15 offset:64
    ds_read_b64_tr_b16 v[26:27], v15 offset:6272
    ds_read_b64_tr_b16 v[28:29], v15 offset:96
    ds_read_b64_tr_b16 v[30:31], v15 offset:6304
    s_waitcnt lgkmcnt(0)
    v_mfma_f32_16x16x32_bf16 v[160:163], v[40:43], v[16:19], v[160:163]
    v_mfma_f32_16x16x32_bf16 v[164:167], v[44:47], v[16:19], v[164:167]
    v_mfma_f32_16x16x32_bf16 v[168:171], v[40:43], v[20:23], v[168:171]
    v_mfma_f32_16x16x32_bf16 v[172:175], v[44:47], v[20:23], v[172:175]
    v_mfma_f32_16x16x32_bf16 v[176:179], v[40:43], v[24:27], v[176:179]
    v_mfma_f32_16x16x32_bf16 v[180:183], v[44:47], v[24:27], v[180:183]
    v_mfma_f32_16x16x32_bf16 v[184:187], v[40:43], v[28:31], v[184:187]
    v_mfma_f32_16x16x32_bf16 v[188:191], v[44:47], v[28:31], v[188:191]
    ds_read_b64_tr_b16 v[16:17], v15 offset:128
    ds_read_b64_tr_b16 v[18:19], v15 offset:6336
    ds_read_b64_tr_b16 v[20:21], v15 offset:160
    ds_read_b64_tr_b16 v[22:23], v15 offset:6368
    ds_read_b64_tr_b16 v[24:25], v15 offset:192
    ds_read_b64_tr_b16 v[26:27], v15 offset:6400
    ds_read_b64_tr_b16 v[28:29], v15 offset:224
    ds_read_b64_tr_b16 v[30:31], v15 offset:6432
    s_waitcnt lgkmcnt(0)
    v_mfma_f32_16x16x32_bf16 v[192:195], v[40:43], v[16:19], v[192:195]
    v_mfma_f32_16x16x32_bf16 v[196:199], v[44:47], v[16:19], v[196:199]
    v_mfma_f32_16x16x32_bf16 v[200:203], v[40:43], v[20:23], v[200:203]
    v_mfma_f32_16x16x32_bf16 v[204:207], v[44:47], v[20:23], v[204:207]
    v_mfma_f32_16x16x32_bf16 v[208:211], v[40:43], v[24:27], v[208:211]
    v_mfma_f32_16x16x32_bf16 v[212:215], v[44:47], v[24:27], v[212:215]
    v_mfma_f32_16x16x32_bf16 v[216:219], v[40:43], v[28:31], v[216:219]
    v_mfma_f32_16x16x32_bf16 v[220:223], v[44:47], v[28:31], v[220:223]
    ds_read_b64_tr_b16 v[16:17], v15 offset:256
    ds_read_b64_tr_b16 v[18:19], v15 offset:6464
    ds_read_b64_tr_b16 v[20:21], v15 offset:288
    ds_read_b64_tr_b16 v[22:23], v15 offset:6496
    ds_read_b64_tr_b16 v[24:25], v15 offset:320
    ds_read_b64_tr_b16 v[26:27], v15 offset:6528
    ds_read_b64_tr_b16 v[28:29], v15 offset:352
    ds_read_b64_tr_b16 v[30:31], v15 offset:6560
    s_waitcnt lgkmcnt(0)
    v_mfma_f32_16x16x32_bf16 v[224:227], v[40:43], v[16:19], v[224:227]
    v_mfma_f32_16x16x32_bf16 v[228:231], v[44:47], v[16:19], v[228:231]
    v_mfma_f32_16x16x32_bf16 v[232:235], v[40:43], v[20:23], v[232:235]
    v_mfma_f32_16x16x32_bf16 v[236:239], v[44:47], v[20:23], v[236:239]
    v_mfma_f32_16x16x32_bf16 v[240:243], v[40:43], v[24:27], v[240:243]
    v_mfma_f32_16x16x32_bf16 v[244:247], v[44:47], v[24:27], v[244:247]
    v_mfma_f32_16x16x32_bf16 v[248:251], v[40:43], v[28:31], v[248:251]
    v_mfma_f32_16x16x32_bf16 v[252:255], v[44:47], v[28:31], v[252:255]
    s_nop 9
    s_barrier
    s_add_u32 s30, s30, 49152
    s_add_u32 s33, s33, 1
    s_cmp_lt_u32 s33, 8
    s_cbranch_scc1 K3_BLOOP
    v_mov_b32 v60, v9
    v_mov_b32 v61, v9
    s_nop 1
    v_permlane32_swap_b32 v60, v61
    s_nop 1
    v_add_f32 v9, v60, v61
    v_mov_b32 v60, v9
    v_mov_b32 v61, v9
    s_nop 1
    v_permlane16_swap_b32 v60, v61
    s_nop 1
    v_add_f32 v9, v60, v61
    v_lshlrev_b32 v7, 2, v5
    s_lshl_b32 s23, s21, 7
    v_add_u32 v47, s23, v7
    s_xor_b32 s23, s23, 128
    v_add_u32 v48, s23, v7
    ds_write_b32 v47, v9 offset:52736
    s_waitcnt lgkmcnt(0)
    s_barrier
    ds_read_b32 v49, v48 offset:52736
    s_waitcnt lgkmcnt(0)
    v_add_f32 v9, v9, v49
    s_mul_i32 s24, s2, 98816
    s_add_u32 s24, s24, 1048576
    s_mov_b32 s25, 3088
    v_mul_lo_u32 v6, v5, s25
    v_add_u32 v6, s24, v6
    v_mov_b32 v10, v8
    v_mov_b32 v11, v9
    buffer_store_dwordx2 v[10:11], v6, s[12:15], 0 offen offset:3072
    v_lshlrev_b32 v6, 2, v4
    v_mul_lo_u32 v6, v6, s25
    v_lshlrev_b32 v7, 2, v3
    s_mul_i32 s26, s20, 768
    s_add_u32 s26, s26, s24
    v_add3_u32 v6, v6, v7, s26
    s_mov_b32 s27, 0
    buffer_store_dword v160, v6, s[12:15], s27 offen offset:0
    buffer_store_dword v168, v6, s[12:15], s27 offen offset:64
    buffer_store_dword v176, v6, s[12:15], s27 offen offset:128
    buffer_store_dword v184, v6, s[12:15], s27 offen offset:192
    buffer_store_dword v192, v6, s[12:15], s27 offen offset:256
    buffer_store_dword v200, v6, s[12:15], s27 offen offset:320
    buffer_store_dword v208, v6, s[12:15], s27 offen offset:384
    buffer_store_dword v216, v6, s[12:15], s27 offen offset:448
    buffer_store_dword v224, v6, s[12:15], s27 offen offset:512
    buffer_store_dword v232, v6, s[12:15], s27 offen offset:576
    buffer_store_dword v240, v6, s[12:15], s27 offen offset:640
    buffer_store_dword v248, v6, s[12:15], s27 offen offset:704
    s_mov_b32 s27, 3088
    buffer_store_dword v161, v6, s[12:15], s27 offen offset:0
    buffer_store_dword v169, v6, s[12:15], s27 offen offset:64
    buffer_store_dword v177, v6, s[12:15], s27 offen offset:128
    buffer_store_dword v185, v6, s[12:15], s27 offen offset:192
    buffer_store_dword v193, v6, s[12:15], s27 offen offset:256
    buffer_store_dword v201, v6, s[12:15], s27 offen offset:320
    buffer_store_dword v209, v6, s[12:15], s27 offen offset:384
    buffer_store_dword v217, v6, s[12:15], s27 offen offset:448
    buffer_store_dword v225, v6, s[12:15], s27 offen offset:512
    buffer_store_dword v233, v6, s[12:15], s27 offen offset:576
    buffer_store_dword v241, v6, s[12:15], s27 offen offset:640
    buffer_store_dword v249, v6, s[12:15], s27 offen offset:704
    s_mov_b32 s27, 6176
    buffer_store_dword v162, v6, s[12:15], s27 offen offset:0
    buffer_store_dword v170, v6, s[12:15], s27 offen offset:64
    buffer_store_dword v178, v6, s[12:15], s27 offen offset:128
    buffer_store_dword v186, v6, s[12:15], s27 offen offset:192
    buffer_store_dword v194, v6, s[12:15], s27 offen offset:256
    buffer_store_dword v202, v6, s[12:15], s27 offen offset:320
    buffer_store_dword v210, v6, s[12:15], s27 offen offset:384
    buffer_store_dword v218, v6, s[12:15], s27 offen offset:448
    buffer_store_dword v226, v6, s[12:15], s27 offen offset:512
    buffer_store_dword v234, v6, s[12:15], s27 offen offset:576
    buffer_store_dword v242, v6, s[12:15], s27 offen offset:640
    buffer_store_dword v250, v6, s[12:15], s27 offen offset:704
    s_mov_b32 s27, 9264
    buffer_store_dword v163, v6, s[12:15], s27 offen offset:0
    buffer_store_dword v171, v6, s[12:15], s27 offen offset:64
    buffer_store_dword v179, v6, s[12:15], s27 offen offset:128
    buffer_store_dword v187, v6, s[12:15], s27 offen offset:192
    buffer_store_dword v195, v6, s[12:15], s27 offen offset:256
    buffer_store_dword v203, v6, s[12:15], s27 offen offset:320
    buffer_store_dword v211, v6, s[12:15], s27 offen offset:384
    buffer_store_dword v219, v6, s[12:15], s27 offen offset:448
    buffer_store_dword v227, v6, s[12:15], s27 offen offset:512
    buffer_store_dword v235, v6, s[12:15], s27 offen offset:576
    buffer_store_dword v243, v6, s[12:15], s27 offen offset:640
    buffer_store_dword v251, v6, s[12:15], s27 offen offset:704
    s_mov_b32 s27, 49408
    buffer_store_dword v164, v6, s[12:15], s27 offen offset:0
    buffer_store_dword v172, v6, s[12:15], s27 offen offset:64
    buffer_store_dword v180, v6, s[12:15], s27 offen offset:128
    buffer_store_dword v188, v6, s[12:15], s27 offen offset:192
    buffer_store_dword v196, v6, s[12:15], s27 offen offset:256
    buffer_store_dword v204, v6, s[12:15], s27 offen offset:320
    buffer_store_dword v212, v6, s[12:15], s27 offen offset:384
    buffer_store_dword v220, v6, s[12:15], s27 offen offset:448
    buffer_store_dword v228, v6, s[12:15], s27 offen offset:512
    buffer_store_dword v236, v6, s[12:15], s27 offen offset:576
    buffer_store_dword v244, v6, s[12:15], s27 offen offset:640
    buffer_store_dword v252, v6, s[12:15], s27 offen offset:704
    s_mov_b32 s27, 52496
    buffer_store_dword v165, v6, s[12:15], s27 offen offset:0
    buffer_store_dword v173, v6, s[12:15], s27 offen offset:64
    buffer_store_dword v181, v6, s[12:15], s27 offen offset:128
    buffer_store_dword v189, v6, s[12:15], s27 offen offset:192
    buffer_store_dword v197, v6, s[12:15], s27 offen offset:256
    buffer_store_dword v205, v6, s[12:15], s27 offen offset:320
    buffer_store_dword v213, v6, s[12:15], s27 offen offset:384
    buffer_store_dword v221, v6, s[12:15], s27 offen offset:448
    buffer_store_dword v229, v6, s[12:15], s27 offen offset:512
    buffer_store_dword v237, v6, s[12:15], s27 offen offset:576
    buffer_store_dword v245, v6, s[12:15], s27 offen offset:640
    buffer_store_dword v253, v6, s[12:15], s27 offen offset:704
    s_mov_b32 s27, 55584
    buffer_store_dword v166, v6, s[12:15], s27 offen offset:0
    buffer_store_dword v174, v6, s[12:15], s27 offen offset:64
    buffer_store_dword v182, v6, s[12:15], s27 offen offset:128
    buffer_store_dword v190, v6, s[12:15], s27 offen offset:192
    buffer_store_dword v198, v6, s[12:15], s27 offen offset:256
    buffer_store_dword v206, v6, s[12:15], s27 offen offset:320
    buffer_store_dword v214, v6, s[12:15], s27 offen offset:384
    buffer_store_dword v222, v6, s[12:15], s27 offen offset:448
    buffer_store_dword v230, v6, s[12:15], s27 offen offset:512
    buffer_store_dword v238, v6, s[12:15], s27 offen offset:576
    buffer_store_dword v246, v6, s[12:15], s27 offen offset:640
    buffer_store_dword v254, v6, s[12:15], s27 offen offset:704
    s_mov_b32 s27, 58672
    buffer_store_dword v167, v6, s[12:15], s27 offen offset:0
    buffer_store_dword v175, v6, s[12:15], s27 offen offset:64
    buffer_store_dword v183, v6, s[12:15], s27 offen offset:128
    buffer_store_dword v191, v6, s[12:15], s27 offen offset:192
    buffer_store_dword v199, v6, s[12:15], s27 offen offset:256
    buffer_store_dword v207, v6, s[12:15], s27 offen offset:320
    buffer_store_dword v215, v6, s[12:15], s27 offen offset:384
    buffer_store_dword v223, v6, s[12:15], s27 offen offset:448
    buffer_store_dword v231, v6, s[12:15], s27 offen offset:512
    buffer_store_dword v239, v6, s[12:15], s27 offen offset:576
    buffer_store_dword v247, v6, s[12:15], s27 offen offset:640
    buffer_store_dword v255, v6, s[12:15], s27 offen offset:704
K3_END:
    s_endpgm
.p2align 8
.type comb_kernel,@function
comb_kernel:
    s_cmp_ge_u32 s2, 224
    s_cbranch_scc1 K4_END
    s_load_dwordx2 s[12:13], s[0:1], 104
    s_mov_b32 s14, 402653184
    s_mov_b32 s15, 0x00020000
    s_cmp_ge_u32 s2, 192
    s_cbranch_scc1 K4_A
    s_load_dwordx2 s[8:9], s[0:1], 72
    s_mov_b32 s10, 9437184
    s_mov_b32 s11, 0x00020000
    s_mov_b32 s21, 0x2aaaaaab
    s_mul_hi_u32 s22, s2, s21
    s_mul_i32 s23, s22, 6
    s_sub_u32 s23, s2, s23
    s_mul_i32 s24, s22, 3088
    s_add_u32 s24, s24, 1048576
    v_lshlrev_b32 v1, 2, v0
    v_add_u32 v1, s24, v1
    v_mov_b32 v2, s24
    s_waitcnt lgkmcnt(0)
    s_mov_b32 s25, 0
    buffer_load_dwordx2 v[16:17], v2, s[12:15], s25 offen offset:3072
    s_add_u32 s25, s25, 98816
    buffer_load_dwordx2 v[18:19], v2, s[12:15], s25 offen offset:3072
    s_add_u32 s25, s25, 98816
    buffer_load_dwordx2 v[20:21], v2, s[12:15], s25 offen offset:3072
    s_add_u32 s25, s25, 98816
    buffer_load_dwordx2 v[22:23], v2, s[12:15], s25 offen offset:3072
    s_add_u32 s25, s25, 98816
    buffer_load_dwordx2 v[24:25], v2, s[12:15], s25 offen offset:3072
    s_add_u32 s25, s25, 98816
    buffer_load_dwordx2 v[26:27], v2, s[12:15], s25 offen offset:3072
    s_add_u32 s25, s25, 98816
    buffer_load_dwordx2 v[28:29], v2, s[12:15], s25 offen offset:3072
    s_add_u32 s25, s25, 98816
    buffer_load_dwordx2 v[30:31], v2, s[12:15], s25 offen offset:3072
    s_add_u32 s25, s25, 98816
    buffer_load_dwordx2 v[32:33], v2, s[12:15], s25 offen offset:3072
    s_add_u32 s25, s25, 98816
    buffer_load_dwordx2 v[34:35], v2, s[12:15], s25 offen offset:3072
    s_add_u32 s25, s25, 98816
    buffer_load_dwordx2 v[36:37], v2, s[12:15], s25 offen offset:3072
    s_add_u32 s25, s25, 98816
    buffer_load_dwordx2 v[38:39], v2, s[12:15], s25 offen offset:3072
    s_add_u32 s25, s25, 98816
    buffer_load_dwordx2 v[40:41], v2, s[12:15], s25 offen offset:3072
    s_add_u32 s25, s25, 98816
    buffer_load_dwordx2 v[42:43], v2, s[12:15], s25 offen offset:3072
    s_add_u32 s25, s25, 98816
    buffer_load_dwordx2 v[44:45], v2, s[12:15], s25 offen offset:3072
    s_add_u32 s25, s25, 98816
    buffer_load_dwordx2 v[46:47], v2, s[12:15], s25 offen offset:3072
    s_add_u32 s25, s25, 98816
    buffer_load_dwordx2 v[48:49], v2, s[12:15], s25 offen offset:3072
    s_add_u32 s25, s25, 98816
    buffer_load_dwordx2 v[50:51], v2, s[12:15], s25 offen offset:3072
    s_add_u32 s25, s25, 98816
    buffer_load_dwordx2 v[52:53], v2, s[12:15], s25 offen offset:3072
    s_add_u32 s25, s25, 98816
    buffer_load_dwordx2 v[54:55], v2, s[12:15], s25 offen offset:3072
    s_add_u32 s25, s25, 98816
    buffer_load_dwordx2 v[56:57], v2, s[12:15], s25 offen offset:3072
    s_add_u32 s25, s25, 98816
    buffer_load_dwordx2 v[58:59], v2, s[12:15], s25 offen offset:3072
    s_add_u32 s25, s25, 98816
    buffer_load_dwordx2 v[60:61], v2, s[12:15], s25 offen offset:3072
    s_add_u32 s25, s25, 98816
    buffer_load_dwordx2 v[62:63], v2, s[12:15], s25 offen offset:3072
    s_add_u32 s25, s25, 98816
    buffer_load_dwordx2 v[64:65], v2, s[12:15], s25 offen offset:3072
    s_add_u32 s25, s25, 98816
    buffer_load_dwordx2 v[66:67], v2, s[12:15], s25 offen offset:3072
    s_add_u32 s25, s25, 98816
    buffer_load_dwordx2 v[68:69], v2, s[12:15], s25 offen offset:3072
    s_add_u32 s25, s25, 98816
    buffer_load_dwordx2 v[70:71], v2, s[12:15], s25 offen offset:3072
    s_add_u32 s25, s25, 98816
    buffer_load_dwordx2 v[72:73], v2, s[12:15], s25 offen offset:3072
    s_add_u32 s25, s25, 98816
    buffer_load_dwordx2 v[74:75], v2, s[12:15], s25 offen offset:3072
    s_add_u32 s25, s25, 98816
    buffer_load_dwordx2 v[76:77], v2, s[12:15], s25 offen offset:3072
    s_add_u32 s25, s25, 98816
    buffer_load_dwordx2 v[78:79], v2, s[12:15], s25 offen offset:3072
    s_add_u32 s25, s25, 98816
    s_waitcnt vmcnt(0)
    v_mov_b32 v3, v16
    v_max_f32 v3, v3, v18
    v_max_f32 v3, v3, v20
    v_max_f32 v3, v3, v22
    v_max_f32 v3, v3, v24
    v_max_f32 v3, v3, v26
    v_max_f32 v3, v3, v28
    v_max_f32 v3, v3, v30
    v_max_f32 v3, v3, v32
    v_max_f32 v3, v3, v34
    v_max_f32 v3, v3, v36
    v_max_f32 v3, v3, v38
    v_max_f32 v3, v3, v40
    v_max_f32 v3, v3, v42
    v_max_f32 v3, v3, v44
    v_max_f32 v3, v3, v46
    v_max_f32 v3, v3, v48
    v_max_f32 v3, v3, v50
    v_max_f32 v3, v3, v52
    v_max_f32 v3, v3, v54
    v_max_f32 v3, v3, v56
    v_max_f32 v3, v3, v58
    v_max_f32 v3, v3, v60
    v_max_f32 v3, v3, v62
    v_max_f32 v3, v3, v64
    v_max_f32 v3, v3, v66
    v_max_f32 v3, v3, v68
    v_max_f32 v3, v3, v70
    v_max_f32 v3, v3, v72
    v_max_f32 v3, v3, v74
    v_max_f32 v3, v3, v76
    v_max_f32 v3, v3, v78
    v_mov_b32 v4, 0
    v_sub_f32 v16, v16, v3
    v_exp_f32 v16, v16
    s_nop 0
    v_fmac_f32 v4, v16, v17
    v_sub_f32 v18, v18, v3
    v_exp_f32 v18, v18
    s_nop 0
    v_fmac_f32 v4, v18, v19
    v_sub_f32 v20, v20, v3
    v_exp_f32 v20, v20
    s_nop 0
    v_fmac_f32 v4, v20, v21
    v_sub_f32 v22, v22, v3
    v_exp_f32 v22, v22
    s_nop 0
    v_fmac_f32 v4, v22, v23
    v_sub_f32 v24, v24, v3
    v_exp_f32 v24, v24
    s_nop 0
    v_fmac_f32 v4, v24, v25
    v_sub_f32 v26, v26, v3
    v_exp_f32 v26, v26
    s_nop 0
    v_fmac_f32 v4, v26, v27
    v_sub_f32 v28, v28, v3
    v_exp_f32 v28, v28
    s_nop 0
    v_fmac_f32 v4, v28, v29
    v_sub_f32 v30, v30, v3
    v_exp_f32 v30, v30
    s_nop 0
    v_fmac_f32 v4, v30, v31
    v_sub_f32 v32, v32, v3
    v_exp_f32 v32, v32
    s_nop 0
    v_fmac_f32 v4, v32, v33
    v_sub_f32 v34, v34, v3
    v_exp_f32 v34, v34
    s_nop 0
    v_fmac_f32 v4, v34, v35
    v_sub_f32 v36, v36, v3
    v_exp_f32 v36, v36
    s_nop 0
    v_fmac_f32 v4, v36, v37
    v_sub_f32 v38, v38, v3
    v_exp_f32 v38, v38
    s_nop 0
    v_fmac_f32 v4, v38, v39
    v_sub_f32 v40, v40, v3
    v_exp_f32 v40, v40
    s_nop 0
    v_fmac_f32 v4, v40, v41
    v_sub_f32 v42, v42, v3
    v_exp_f32 v42, v42
    s_nop 0
    v_fmac_f32 v4, v42, v43
    v_sub_f32 v44, v44, v3
    v_exp_f32 v44, v44
    s_nop 0
    v_fmac_f32 v4, v44, v45
    v_sub_f32 v46, v46, v3
    v_exp_f32 v46, v46
    s_nop 0
    v_fmac_f32 v4, v46, v47
    v_sub_f32 v48, v48, v3
    v_exp_f32 v48, v48
    s_nop 0
    v_fmac_f32 v4, v48, v49
    v_sub_f32 v50, v50, v3
    v_exp_f32 v50, v50
    s_nop 0
    v_fmac_f32 v4, v50, v51
    v_sub_f32 v52, v52, v3
    v_exp_f32 v52, v52
    s_nop 0
    v_fmac_f32 v4, v52, v53
    v_sub_f32 v54, v54, v3
    v_exp_f32 v54, v54
    s_nop 0
    v_fmac_f32 v4, v54, v55
    v_sub_f32 v56, v56, v3
    v_exp_f32 v56, v56
    s_nop 0
    v_fmac_f32 v4, v56, v57
    v_sub_f32 v58, v58, v3
    v_exp_f32 v58, v58
    s_nop 0
    v_fmac_f32 v4, v58, v59
    v_sub_f32 v60, v60, v3
    v_exp_f32 v60, v60
    s_nop 0
    v_fmac_f32 v4, v60, v61
    v_sub_f32 v62, v62, v3
    v_exp_f32 v62, v62
    s_nop 0
    v_fmac_f32 v4, v62, v63
    v_sub_f32 v64, v64, v3
    v_exp_f32 v64, v64
    s_nop 0
    v_fmac_f32 v4, v64, v65
    v_sub_f32 v66, v66, v3
    v_exp_f32 v66, v66
    s_nop 0
    v_fmac_f32 v4, v66, v67
    v_sub_f32 v68, v68, v3
    v_exp_f32 v68, v68
    s_nop 0
    v_fmac_f32 v4, v68, v69
    v_sub_f32 v70, v70, v3
    v_exp_f32 v70, v70
    s_nop 0
    v_fmac_f32 v4, v70, v71
    v_sub_f32 v72, v72, v3
    v_exp_f32 v72, v72
    s_nop 0
    v_fmac_f32 v4, v72, v73
    v_sub_f32 v74, v74, v3
    v_exp_f32 v74, v74
    s_nop 0
    v_fmac_f32 v4, v74, v75
    v_sub_f32 v76, v76, v3
    v_exp_f32 v76, v76
    s_nop 0
    v_fmac_f32 v4, v76, v77
    v_sub_f32 v78, v78, v3
    v_exp_f32 v78, v78
    s_nop 0
    v_fmac_f32 v4, v78, v79
    v_rcp_f32 v4, v4
    v_mov_b32 v5, 0
    v_mov_b32 v6, 0
    v_mov_b32 v7, 0
    s_mov_b32 s25, 0
    buffer_load_dword v96, v1, s[12:15], s25 offen offset:0
    buffer_load_dword v97, v1, s[12:15], s25 offen offset:1024
    buffer_load_dword v98, v1, s[12:15], s25 offen offset:2048
    s_add_u32 s25, s25, 98816
    buffer_load_dword v99, v1, s[12:15], s25 offen offset:0
    buffer_load_dword v100, v1, s[12:15], s25 offen offset:1024
    buffer_load_dword v101, v1, s[12:15], s25 offen offset:2048
    s_add_u32 s25, s25, 98816
    buffer_load_dword v102, v1, s[12:15], s25 offen offset:0
    buffer_load_dword v103, v1, s[12:15], s25 offen offset:1024
    buffer_load_dword v104, v1, s[12:15], s25 offen offset:2048
    s_add_u32 s25, s25, 98816
    buffer_load_dword v105, v1, s[12:15], s25 offen offset:0
    buffer_load_dword v106, v1, s[12:15], s25 offen offset:1024
    buffer_load_dword v107, v1, s[12:15], s25 offen offset:2048
    s_add_u32 s25, s25, 98816
    buffer_load_dword v108, v1, s[12:15], s25 offen offset:0
    buffer_load_dword v109, v1, s[12:15], s25 offen offset:1024
    buffer_load_dword v110, v1, s[12:15], s25 offen offset:2048
    s_add_u32 s25, s25, 98816
    buffer_load_dword v111, v1, s[12:15], s25 offen offset:0
    buffer_load_dword v112, v1, s[12:15], s25 offen offset:1024
    buffer_load_dword v113, v1, s[12:15], s25 offen offset:2048
    s_add_u32 s25, s25, 98816
    buffer_load_dword v114, v1, s[12:15], s25 offen offset:0
    buffer_load_dword v115, v1, s[12:15], s25 offen offset:1024
    buffer_load_dword v116, v1, s[12:15], s25 offen offset:2048
    s_add_u32 s25, s25, 98816
    buffer_load_dword v117, v1, s[12:15], s25 offen offset:0
    buffer_load_dword v118, v1, s[12:15], s25 offen offset:1024
    buffer_load_dword v119, v1, s[12:15], s25 offen offset:2048
    s_add_u32 s25, s25, 98816
    s_waitcnt vmcnt(0)
    v_fmac_f32 v5, v16, v96
    v_fmac_f32 v6, v16, v97
    v_fmac_f32 v7, v16, v98
    v_fmac_f32 v5, v18, v99
    v_fmac_f32 v6, v18, v100
    v_fmac_f32 v7, v18, v101
    v_fmac_f32 v5, v20, v102
    v_fmac_f32 v6, v20, v103
    v_fmac_f32 v7, v20, v104
    v_fmac_f32 v5, v22, v105
    v_fmac_f32 v6, v22, v106
    v_fmac_f32 v7, v22, v107
    v_fmac_f32 v5, v24, v108
    v_fmac_f32 v6, v24, v109
    v_fmac_f32 v7, v24, v110
    v_fmac_f32 v5, v26, v111
    v_fmac_f32 v6, v26, v112
    v_fmac_f32 v7, v26, v113
    v_fmac_f32 v5, v28, v114
    v_fmac_f32 v6, v28, v115
    v_fmac_f32 v7, v28, v116
    v_fmac_f32 v5, v30, v117
    v_fmac_f32 v6, v30, v118
    v_fmac_f32 v7, v30, v119
    buffer_load_dword v96, v1, s[12:15], s25 offen offset:0
    buffer_load_dword v97, v1, s[12:15], s25 offen offset:1024
    buffer_load_dword v98, v1, s[12:15], s25 offen offset:2048
    s_add_u32 s25, s25, 98816
    buffer_load_dword v99, v1, s[12:15], s25 offen offset:0
    buffer_load_dword v100, v1, s[12:15], s25 offen offset:1024
    buffer_load_dword v101, v1, s[12:15], s25 offen offset:2048
    s_add_u32 s25, s25, 98816
    buffer_load_dword v102, v1, s[12:15], s25 offen offset:0
    buffer_load_dword v103, v1, s[12:15], s25 offen offset:1024
    buffer_load_dword v104, v1, s[12:15], s25 offen offset:2048
    s_add_u32 s25, s25, 98816
    buffer_load_dword v105, v1, s[12:15], s25 offen offset:0
    buffer_load_dword v106, v1, s[12:15], s25 offen offset:1024
    buffer_load_dword v107, v1, s[12:15], s25 offen offset:2048
    s_add_u32 s25, s25, 98816
    buffer_load_dword v108, v1, s[12:15], s25 offen offset:0
    buffer_load_dword v109, v1, s[12:15], s25 offen offset:1024
    buffer_load_dword v110, v1, s[12:15], s25 offen offset:2048
    s_add_u32 s25, s25, 98816
    buffer_load_dword v111, v1, s[12:15], s25 offen offset:0
    buffer_load_dword v112, v1, s[12:15], s25 offen offset:1024
    buffer_load_dword v113, v1, s[12:15], s25 offen offset:2048
    s_add_u32 s25, s25, 98816
    buffer_load_dword v114, v1, s[12:15], s25 offen offset:0
    buffer_load_dword v115, v1, s[12:15], s25 offen offset:1024
    buffer_load_dword v116, v1, s[12:15], s25 offen offset:2048
    s_add_u32 s25, s25, 98816
    buffer_load_dword v117, v1, s[12:15], s25 offen offset:0
    buffer_load_dword v118, v1, s[12:15], s25 offen offset:1024
    buffer_load_dword v119, v1, s[12:15], s25 offen offset:2048
    s_add_u32 s25, s25, 98816
    s_waitcnt vmcnt(0)
    v_fmac_f32 v5, v32, v96
    v_fmac_f32 v6, v32, v97
    v_fmac_f32 v7, v32, v98
    v_fmac_f32 v5, v34, v99
    v_fmac_f32 v6, v34, v100
    v_fmac_f32 v7, v34, v101
    v_fmac_f32 v5, v36, v102
    v_fmac_f32 v6, v36, v103
    v_fmac_f32 v7, v36, v104
    v_fmac_f32 v5, v38, v105
    v_fmac_f32 v6, v38, v106
    v_fmac_f32 v7, v38, v107
    v_fmac_f32 v5, v40, v108
    v_fmac_f32 v6, v40, v109
    v_fmac_f32 v7, v40, v110
    v_fmac_f32 v5, v42, v111
    v_fmac_f32 v6, v42, v112
    v_fmac_f32 v7, v42, v113
    v_fmac_f32 v5, v44, v114
    v_fmac_f32 v6, v44, v115
    v_fmac_f32 v7, v44, v116
    v_fmac_f32 v5, v46, v117
    v_fmac_f32 v6, v46, v118
    v_fmac_f32 v7, v46, v119
    buffer_load_dword v96, v1, s[12:15], s25 offen offset:0
    buffer_load_dword v97, v1, s[12:15], s25 offen offset:1024
    buffer_load_dword v98, v1, s[12:15], s25 offen offset:2048
    s_add_u32 s25, s25, 98816
    buffer_load_dword v99, v1, s[12:15], s25 offen offset:0
    buffer_load_dword v100, v1, s[12:15], s25 offen offset:1024
    buffer_load_dword v101, v1, s[12:15], s25 offen offset:2048
    s_add_u32 s25, s25, 98816
    buffer_load_dword v102, v1, s[12:15], s25 offen offset:0
    buffer_load_dword v103, v1, s[12:15], s25 offen offset:1024
    buffer_load_dword v104, v1, s[12:15], s25 offen offset:2048
    s_add_u32 s25, s25, 98816
    buffer_load_dword v105, v1, s[12:15], s25 offen offset:0
    buffer_load_dword v106, v1, s[12:15], s25 offen offset:1024
    buffer_load_dword v107, v1, s[12:15], s25 offen offset:2048
    s_add_u32 s25, s25, 98816
    buffer_load_dword v108, v1, s[12:15], s25 offen offset:0
    buffer_load_dword v109, v1, s[12:15], s25 offen offset:1024
    buffer_load_dword v110, v1, s[12:15], s25 offen offset:2048
    s_add_u32 s25, s25, 98816
    buffer_load_dword v111, v1, s[12:15], s25 offen offset:0
    buffer_load_dword v112, v1, s[12:15], s25 offen offset:1024
    buffer_load_dword v113, v1, s[12:15], s25 offen offset:2048
    s_add_u32 s25, s25, 98816
    buffer_load_dword v114, v1, s[12:15], s25 offen offset:0
    buffer_load_dword v115, v1, s[12:15], s25 offen offset:1024
    buffer_load_dword v116, v1, s[12:15], s25 offen offset:2048
    s_add_u32 s25, s25, 98816
    buffer_load_dword v117, v1, s[12:15], s25 offen offset:0
    buffer_load_dword v118, v1, s[12:15], s25 offen offset:1024
    buffer_load_dword v119, v1, s[12:15], s25 offen offset:2048
    s_add_u32 s25, s25, 98816
    s_waitcnt vmcnt(0)
    v_fmac_f32 v5, v48, v96
    v_fmac_f32 v6, v48, v97
    v_fmac_f32 v7, v48, v98
    v_fmac_f32 v5, v50, v99
    v_fmac_f32 v6, v50, v100
    v_fmac_f32 v7, v50, v101
    v_fmac_f32 v5, v52, v102
    v_fmac_f32 v6, v52, v103
    v_fmac_f32 v7, v52, v104
    v_fmac_f32 v5, v54, v105
    v_fmac_f32 v6, v54, v106
    v_fmac_f32 v7, v54, v107
    v_fmac_f32 v5, v56, v108
    v_fmac_f32 v6, v56, v109
    v_fmac_f32 v7, v56, v110
    v_fmac_f32 v5, v58, v111
    v_fmac_f32 v6, v58, v112
    v_fmac_f32 v7, v58, v113
    v_fmac_f32 v5, v60, v114
    v_fmac_f32 v6, v60, v115
    v_fmac_f32 v7, v60, v116
    v_fmac_f32 v5, v62, v117
    v_fmac_f32 v6, v62, v118
    v_fmac_f32 v7, v62, v119
    buffer_load_dword v96, v1, s[12:15], s25 offen offset:0
    buffer_load_dword v97, v1, s[12:15], s25 offen offset:1024
    buffer_load_dword v98, v1, s[12:15], s25 offen offset:2048
    s_add_u32 s25, s25, 98816
    buffer_load_dword v99, v1, s[12:15], s25 offen offset:0
    buffer_load_dword v100, v1, s[12:15], s25 offen offset:1024
    buffer_load_dword v101, v1, s[12:15], s25 offen offset:2048
    s_add_u32 s25, s25, 98816
    buffer_load_dword v102, v1, s[12:15], s25 offen offset:0
    buffer_load_dword v103, v1, s[12:15], s25 offen offset:1024
    buffer_load_dword v104, v1, s[12:15], s25 offen offset:2048
    s_add_u32 s25, s25, 98816
    buffer_load_dword v105, v1, s[12:15], s25 offen offset:0
    buffer_load_dword v106, v1, s[12:15], s25 offen offset:1024
    buffer_load_dword v107, v1, s[12:15], s25 offen offset:2048
    s_add_u32 s25, s25, 98816
    buffer_load_dword v108, v1, s[12:15], s25 offen offset:0
    buffer_load_dword v109, v1, s[12:15], s25 offen offset:1024
    buffer_load_dword v110, v1, s[12:15], s25 offen offset:2048
    s_add_u32 s25, s25, 98816
    buffer_load_dword v111, v1, s[12:15], s25 offen offset:0
    buffer_load_dword v112, v1, s[12:15], s25 offen offset:1024
    buffer_load_dword v113, v1, s[12:15], s25 offen offset:2048
    s_add_u32 s25, s25, 98816
    buffer_load_dword v114, v1, s[12:15], s25 offen offset:0
    buffer_load_dword v115, v1, s[12:15], s25 offen offset:1024
    buffer_load_dword v116, v1, s[12:15], s25 offen offset:2048
    s_add_u32 s25, s25, 98816
    buffer_load_dword v117, v1, s[12:15], s25 offen offset:0
    buffer_load_dword v118, v1, s[12:15], s25 offen offset:1024
    buffer_load_dword v119, v1, s[12:15], s25 offen offset:2048
    s_add_u32 s25, s25, 98816
    s_waitcnt vmcnt(0)
    v_fmac_f32 v5, v64, v96
    v_fmac_f32 v6, v64, v97
    v_fmac_f32 v7, v64, v98
    v_fmac_f32 v5, v66, v99
    v_fmac_f32 v6, v66, v100
    v_fmac_f32 v7, v66, v101
    v_fmac_f32 v5, v68, v102
    v_fmac_f32 v6, v68, v103
    v_fmac_f32 v7, v68, v104
    v_fmac_f32 v5, v70, v105
    v_fmac_f32 v6, v70, v106
    v_fmac_f32 v7, v70, v107
    v_fmac_f32 v5, v72, v108
    v_fmac_f32 v6, v72, v109
    v_fmac_f32 v7, v72, v110
    v_fmac_f32 v5, v74, v111
    v_fmac_f32 v6, v74, v112
    v_fmac_f32 v7, v74, v113
    v_fmac_f32 v5, v76, v114
    v_fmac_f32 v6, v76, v115
    v_fmac_f32 v7, v76, v116
    v_fmac_f32 v5, v78, v117
    v_fmac_f32 v6, v78, v118
    v_fmac_f32 v7, v78, v119
    v_lshlrev_b32 v1, 2, v0
    v_mul_f32 v5, v5, v4
    ds_write_b32 v1, v5 offset:0
    v_mul_f32 v6, v6, v4
    ds_write_b32 v1, v6 offset:1024
    v_mul_f32 v7, v7, v4
    ds_write_b32 v1, v7 offset:2048
    s_waitcnt lgkmcnt(0)
    s_barrier
    v_lshrrev_b32 v6, 2, v0
    v_lshlrev_b32 v7, 2, v6
    s_mov_b32 s26, 12288
    v_mul_lo_u32 v8, v6, s26
    v_and_b32 v9, 3, v0
    v_lshlrev_b32 v9, 4, v9
    v_add_u32 v8, v8, v9
    s_mul_i32 s26, s22, 384
    s_lshl_b32 s27, s23, 6
    s_add_u32 s26, s26, s27
    v_add_u32 v8, s26, v8
    s_mov_b32 s28, 0
    buffer_load_dwordx4 v[32:35], v8, s[8:11], s28 offen
    s_add_u32 s28, s28, 786432
    buffer_load_dwordx4 v[36:39], v8, s[8:11], s28 offen
    s_add_u32 s28, s28, 786432
    buffer_load_dwordx4 v[40:43], v8, s[8:11], s28 offen
    s_add_u32 s28, s28, 786432
    buffer_load_dwordx4 v[44:47], v8, s[8:11], s28 offen
    s_add_u32 s28, s28, 786432
    buffer_load_dwordx4 v[48:51], v8, s[8:11], s28 offen
    s_add_u32 s28, s28, 786432
    buffer_load_dwordx4 v[52:55], v8, s[8:11], s28 offen
    s_add_u32 s28, s28, 786432
    buffer_load_dwordx4 v[56:59], v8, s[8:11], s28 offen
    s_add_u32 s28, s28, 786432
    buffer_load_dwordx4 v[60:63], v8, s[8:11], s28 offen
    s_add_u32 s28, s28, 786432
    buffer_load_dwordx4 v[64:67], v8, s[8:11], s28 offen
    s_add_u32 s28, s28, 786432
    buffer_load_dwordx4 v[68:71], v8, s[8:11], s28 offen
    s_add_u32 s28, s28, 786432
    buffer_load_dwordx4 v[72:75], v8, s[8:11], s28 offen
    s_add_u32 s28, s28, 786432
    buffer_load_dwordx4 v[76:79], v8, s[8:11], s28 offen
    v_mov_b32 v16, 0
    v_mov_b32 v17, 0
    v_mov_b32 v18, 0
    v_mov_b32 v19, 0
    v_mov_b32 v20, 0
    v_mov_b32 v21, 0
    v_mov_b32 v22, 0
    v_mov_b32 v23, 0
    ds_read_b32 v96, v7 offset:0
    s_waitcnt vmcnt(11) lgkmcnt(0)
    v_lshlrev_b32 v97, 16, v32
    v_and_b32 v98, 0xffff0000, v32
    v_fmac_f32 v16, v96, v97
    v_fmac_f32 v17, v96, v98
    v_lshlrev_b32 v97, 16, v33
    v_and_b32 v98, 0xffff0000, v33
    v_fmac_f32 v18, v96, v97
    v_fmac_f32 v19, v96, v98
    v_lshlrev_b32 v97, 16, v34
    v_and_b32 v98, 0xffff0000, v34
    v_fmac_f32 v20, v96, v97
    v_fmac_f32 v21, v96, v98
    v_lshlrev_b32 v97, 16, v35
    v_and_b32 v98, 0xffff0000, v35
    v_fmac_f32 v22, v96, v97
    v_fmac_f32 v23, v96, v98
    ds_read_b32 v96, v7 offset:256
    s_waitcnt vmcnt(10) lgkmcnt(0)
    v_lshlrev_b32 v97, 16, v36
    v_and_b32 v98, 0xffff0000, v36
    v_fmac_f32 v16, v96, v97
    v_fmac_f32 v17, v96, v98
    v_lshlrev_b32 v97, 16, v37
    v_and_b32 v98, 0xffff0000, v37
    v_fmac_f32 v18, v96, v97
    v_fmac_f32 v19, v96, v98
    v_lshlrev_b32 v97, 16, v38
    v_and_b32 v98, 0xffff0000, v38
    v_fmac_f32 v20, v96, v97
    v_fmac_f32 v21, v96, v98
    v_lshlrev_b32 v97, 16, v39
    v_and_b32 v98, 0xffff0000, v39
    v_fmac_f32 v22, v96, v97
    v_fmac_f32 v23, v96, v98
    ds_read_b32 v96, v7 offset:512
    s_waitcnt vmcnt(9) lgkmcnt(0)
    v_lshlrev_b32 v97, 16, v40
    v_and_b32 v98, 0xffff0000, v40
    v_fmac_f32 v16, v96, v97
    v_fmac_f32 v17, v96, v98
    v_lshlrev_b32 v97, 16, v41
    v_and_b32 v98, 0xffff0000, v41
    v_fmac_f32 v18, v96, v97
    v_fmac_f32 v19, v96, v98
    v_lshlrev_b32 v97, 16, v42
    v_and_b32 v98, 0xffff0000, v42
    v_fmac_f32 v20, v96, v97
    v_fmac_f32 v21, v96, v98
    v_lshlrev_b32 v97, 16, v43
    v_and_b32 v98, 0xffff0000, v43
    v_fmac_f32 v22, v96, v97
    v_fmac_f32 v23, v96, v98
    ds_read_b32 v96, v7 offset:768
    s_waitcnt vmcnt(8) lgkmcnt(0)
    v_lshlrev_b32 v97, 16, v44
    v_and_b32 v98, 0xffff0000, v44
    v_fmac_f32 v16, v96, v97
    v_fmac_f32 v17, v96, v98
    v_lshlrev_b32 v97, 16, v45
    v_and_b32 v98, 0xffff0000, v45
    v_fmac_f32 v18, v96, v97
    v_fmac_f32 v19, v96, v98
    v_lshlrev_b32 v97, 16, v46
    v_and_b32 v98, 0xffff0000, v46
    v_fmac_f32 v20, v96, v97
    v_fmac_f32 v21, v96, v98
    v_lshlrev_b32 v97, 16, v47
    v_and_b32 v98, 0xffff0000, v47
    v_fmac_f32 v22, v96, v97
    v_fmac_f32 v23, v96, v98
    ds_read_b32 v96, v7 offset:1024
    s_waitcnt vmcnt(7) lgkmcnt(0)
    v_lshlrev_b32 v97, 16, v48
    v_and_b32 v98, 0xffff0000, v48
    v_fmac_f32 v16, v96, v97
    v_fmac_f32 v17, v96, v98
    v_lshlrev_b32 v97, 16, v49
    v_and_b32 v98, 0xffff0000, v49
    v_fmac_f32 v18, v96, v97
    v_fmac_f32 v19, v96, v98
    v_lshlrev_b32 v97, 16, v50
    v_and_b32 v98, 0xffff0000, v50
    v_fmac_f32 v20, v96, v97
    v_fmac_f32 v21, v96, v98
    v_lshlrev_b32 v97, 16, v51
    v_and_b32 v98, 0xffff0000, v51
    v_fmac_f32 v22, v96, v97
    v_fmac_f32 v23, v96, v98
    ds_read_b32 v96, v7 offset:1280
    s_waitcnt vmcnt(6) lgkmcnt(0)
    v_lshlrev_b32 v97, 16, v52
    v_and_b32 v98, 0xffff0000, v52
    v_fmac_f32 v16, v96, v97
    v_fmac_f32 v17, v96, v98
    v_lshlrev_b32 v97, 16, v53
    v_and_b32 v98, 0xffff0000, v53
    v_fmac_f32 v18, v96, v97
    v_fmac_f32 v19, v96, v98
    v_lshlrev_b32 v97, 16, v54
    v_and_b32 v98, 0xffff0000, v54
    v_fmac_f32 v20, v96, v97
    v_fmac_f32 v21, v96, v98
    v_lshlrev_b32 v97, 16, v55
    v_and_b32 v98, 0xffff0000, v55
    v_fmac_f32 v22, v96, v97
    v_fmac_f32 v23, v96, v98
    ds_read_b32 v96, v7 offset:1536
    s_waitcnt vmcnt(5) lgkmcnt(0)
    v_lshlrev_b32 v97, 16, v56
    v_and_b32 v98, 0xffff0000, v56
    v_fmac_f32 v16, v96, v97
    v_fmac_f32 v17, v96, v98
    v_lshlrev_b32 v97, 16, v57
    v_and_b32 v98, 0xffff0000, v57
    v_fmac_f32 v18, v96, v97
    v_fmac_f32 v19, v96, v98
    v_lshlrev_b32 v97, 16, v58
    v_and_b32 v98, 0xffff0000, v58
    v_fmac_f32 v20, v96, v97
    v_fmac_f32 v21, v96, v98
    v_lshlrev_b32 v97, 16, v59
    v_and_b32 v98, 0xffff0000, v59
    v_fmac_f32 v22, v96, v97
    v_fmac_f32 v23, v96, v98
    ds_read_b32 v96, v7 offset:1792
    s_waitcnt vmcnt(4) lgkmcnt(0)
    v_lshlrev_b32 v97, 16, v60
    v_and_b32 v98, 0xffff0000, v60
    v_fmac_f32 v16, v96, v97
    v_fmac_f32 v17, v96, v98
    v_lshlrev_b32 v97, 16, v61
    v_and_b32 v98, 0xffff0000, v61
    v_fmac_f32 v18, v96, v97
    v_fmac_f32 v19, v96, v98
    v_lshlrev_b32 v97, 16, v62
    v_and_b32 v98, 0xffff0000, v62
    v_fmac_f32 v20, v96, v97
    v_fmac_f32 v21, v96, v98
    v_lshlrev_b32 v97, 16, v63
    v_and_b32 v98, 0xffff0000, v63
    v_fmac_f32 v22, v96, v97
    v_fmac_f32 v23, v96, v98
    ds_read_b32 v96, v7 offset:2048
    s_waitcnt vmcnt(3) lgkmcnt(0)
    v_lshlrev_b32 v97, 16, v64
    v_and_b32 v98, 0xffff0000, v64
    v_fmac_f32 v16, v96, v97
    v_fmac_f32 v17, v96, v98
    v_lshlrev_b32 v97, 16, v65
    v_and_b32 v98, 0xffff0000, v65
    v_fmac_f32 v18, v96, v97
    v_fmac_f32 v19, v96, v98
    v_lshlrev_b32 v97, 16, v66
    v_and_b32 v98, 0xffff0000, v66
    v_fmac_f32 v20, v96, v97
    v_fmac_f32 v21, v96, v98
    v_lshlrev_b32 v97, 16, v67
    v_and_b32 v98, 0xffff0000, v67
    v_fmac_f32 v22, v96, v97
    v_fmac_f32 v23, v96, v98
    ds_read_b32 v96, v7 offset:2304
    s_waitcnt vmcnt(2) lgkmcnt(0)
    v_lshlrev_b32 v97, 16, v68
    v_and_b32 v98, 0xffff0000, v68
    v_fmac_f32 v16, v96, v97
    v_fmac_f32 v17, v96, v98
    v_lshlrev_b32 v97, 16, v69
    v_and_b32 v98, 0xffff0000, v69
    v_fmac_f32 v18, v96, v97
    v_fmac_f32 v19, v96, v98
    v_lshlrev_b32 v97, 16, v70
    v_and_b32 v98, 0xffff0000, v70
    v_fmac_f32 v20, v96, v97
    v_fmac_f32 v21, v96, v98
    v_lshlrev_b32 v97, 16, v71
    v_and_b32 v98, 0xffff0000, v71
    v_fmac_f32 v22, v96, v97
    v_fmac_f32 v23, v96, v98
    ds_read_b32 v96, v7 offset:2560
    s_waitcnt vmcnt(1) lgkmcnt(0)
    v_lshlrev_b32 v97, 16, v72
    v_and_b32 v98, 0xffff0000, v72
    v_fmac_f32 v16, v96, v97
    v_fmac_f32 v17, v96, v98
    v_lshlrev_b32 v97, 16, v73
    v_and_b32 v98, 0xffff0000, v73
    v_fmac_f32 v18, v96, v97
    v_fmac_f32 v19, v96, v98
    v_lshlrev_b32 v97, 16, v74
    v_and_b32 v98, 0xffff0000, v74
    v_fmac_f32 v20, v96, v97
    v_fmac_f32 v21, v96, v98
    v_lshlrev_b32 v97, 16, v75
    v_and_b32 v98, 0xffff0000, v75
    v_fmac_f32 v22, v96, v97
    v_fmac_f32 v23, v96, v98
    ds_read_b32 v96, v7 offset:2816
    s_waitcnt vmcnt(0) lgkmcnt(0)
    v_lshlrev_b32 v97, 16, v76
    v_and_b32 v98, 0xffff0000, v76
    v_fmac_f32 v16, v96, v97
    v_fmac_f32 v17, v96, v98
    v_lshlrev_b32 v97, 16, v77
    v_and_b32 v98, 0xffff0000, v77
    v_fmac_f32 v18, v96, v97
    v_fmac_f32 v19, v96, v98
    v_lshlrev_b32 v97, 16, v78
    v_and_b32 v98, 0xffff0000, v78
    v_fmac_f32 v20, v96, v97
    v_fmac_f32 v21, v96, v98
    v_lshlrev_b32 v97, 16, v79
    v_and_b32 v98, 0xffff0000, v79
    v_fmac_f32 v22, v96, v97
    v_fmac_f32 v23, v96, v98
    v_lshlrev_b32 v96, 5, v0
    ds_write_b128 v96, v[16:19] offset:4096
    ds_write_b128 v96, v[20:23] offset:4112
    s_waitcnt lgkmcnt(0)
    s_barrier
    v_lshlrev_b32 v97, 2, v0
    v_mov_b32 v96, 0
    v_min_u32 v97, 124, v97
    ds_read_b32 v98, v97 offset:4096
    ds_read_b32 v99, v97 offset:4224
    ds_read_b32 v100, v97 offset:4352
    ds_read_b32 v101, v97 offset:4480
    ds_read_b32 v102, v97 offset:4608
    ds_read_b32 v103, v97 offset:4736
    ds_read_b32 v104, v97 offset:4864
    ds_read_b32 v105, v97 offset:4992
    s_waitcnt lgkmcnt(0)
    v_add_f32 v96, v96, v98
    v_add_f32 v96, v96, v99
    v_add_f32 v96, v96, v100
    v_add_f32 v96, v96, v101
    v_add_f32 v96, v96, v102
    v_add_f32 v96, v96, v103
    v_add_f32 v96, v96, v104
    v_add_f32 v96, v96, v105
    ds_read_b32 v98, v97 offset:5120
    ds_read_b32 v99, v97 offset:5248
    ds_read_b32 v100, v97 offset:5376
    ds_read_b32 v101, v97 offset:5504
    ds_read_b32 v102, v97 offset:5632
    ds_read_b32 v103, v97 offset:5760
    ds_read_b32 v104, v97 offset:5888
    ds_read_b32 v105, v97 offset:6016
    s_waitcnt lgkmcnt(0)
    v_add_f32 v96, v96, v98
    v_add_f32 v96, v96, v99
    v_add_f32 v96, v96, v100
    v_add_f32 v96, v96, v101
    v_add_f32 v96, v96, v102
    v_add_f32 v96, v96, v103
    v_add_f32 v96, v96, v104
    v_add_f32 v96, v96, v105
    ds_read_b32 v98, v97 offset:6144
    ds_read_b32 v99, v97 offset:6272
    ds_read_b32 v100, v97 offset:6400
    ds_read_b32 v101, v97 offset:6528
    ds_read_b32 v102, v97 offset:6656
    ds_read_b32 v103, v97 offset:6784
    ds_read_b32 v104, v97 offset:6912
    ds_read_b32 v105, v97 offset:7040
    s_waitcnt lgkmcnt(0)
    v_add_f32 v96, v96, v98
    v_add_f32 v96, v96, v99
    v_add_f32 v96, v96, v100
    v_add_f32 v96, v96, v101
    v_add_f32 v96, v96, v102
    v_add_f32 v96, v96, v103
    v_add_f32 v96, v96, v104
    v_add_f32 v96, v96, v105
    ds_read_b32 v98, v97 offset:7168
    ds_read_b32 v99, v97 offset:7296
    ds_read_b32 v100, v97 offset:7424
    ds_read_b32 v101, v97 offset:7552
    ds_read_b32 v102, v97 offset:7680
    ds_read_b32 v103, v97 offset:7808
    ds_read_b32 v104, v97 offset:7936
    ds_read_b32 v105, v97 offset:8064
    s_waitcnt lgkmcnt(0)
    v_add_f32 v96, v96, v98
    v_add_f32 v96, v96, v99
    v_add_f32 v96, v96, v100
    v_add_f32 v96, v96, v101
    v_add_f32 v96, v96, v102
    v_add_f32 v96, v96, v103
    v_add_f32 v96, v96, v104
    v_add_f32 v96, v96, v105
    ds_read_b32 v98, v97 offset:8192
    ds_read_b32 v99, v97 offset:8320
    ds_read_b32 v100, v97 offset:8448
    ds_read_b32 v101, v97 offset:8576
    ds_read_b32 v102, v97 offset:8704
    ds_read_b32 v103, v97 offset:8832
    ds_read_b32 v104, v97 offset:8960
    ds_read_b32 v105, v97 offset:9088
    s_waitcnt lgkmcnt(0)
    v_add_f32 v96, v96, v98
    v_add_f32 v96, v96, v99
    v_add_f32 v96, v96, v100
    v_add_f32 v96, v96, v101
    v_add_f32 v96, v96, v102
    v_add_f32 v96, v96, v103
    v_add_f32 v96, v96, v104
    v_add_f32 v96, v96, v105
    ds_read_b32 v98, v97 offset:9216
    ds_read_b32 v99, v97 offset:9344
    ds_read_b32 v100, v97 offset:9472
    ds_read_b32 v101, v97 offset:9600
    ds_read_b32 v102, v97 offset:9728
    ds_read_b32 v103, v97 offset:9856
    ds_read_b32 v104, v97 offset:9984
    ds_read_b32 v105, v97 offset:10112
    s_waitcnt lgkmcnt(0)
    v_add_f32 v96, v96, v98
    v_add_f32 v96, v96, v99
    v_add_f32 v96, v96, v100
    v_add_f32 v96, v96, v101
    v_add_f32 v96, v96, v102
    v_add_f32 v96, v96, v103
    v_add_f32 v96, v96, v104
    v_add_f32 v96, v96, v105
    ds_read_b32 v98, v97 offset:10240
    ds_read_b32 v99, v97 offset:10368
    ds_read_b32 v100, v97 offset:10496
    ds_read_b32 v101, v97 offset:10624
    ds_read_b32 v102, v97 offset:10752
    ds_read_b32 v103, v97 offset:10880
    ds_read_b32 v104, v97 offset:11008
    ds_read_b32 v105, v97 offset:11136
    s_waitcnt lgkmcnt(0)
    v_add_f32 v96, v96, v98
    v_add_f32 v96, v96, v99
    v_add_f32 v96, v96, v100
    v_add_f32 v96, v96, v101
    v_add_f32 v96, v96, v102
    v_add_f32 v96, v96, v103
    v_add_f32 v96, v96, v104
    v_add_f32 v96, v96, v105
    ds_read_b32 v98, v97 offset:11264
    ds_read_b32 v99, v97 offset:11392
    ds_read_b32 v100, v97 offset:11520
    ds_read_b32 v101, v97 offset:11648
    ds_read_b32 v102, v97 offset:11776
    ds_read_b32 v103, v97 offset:11904
    ds_read_b32 v104, v97 offset:12032
    ds_read_b32 v105, v97 offset:12160
    s_waitcnt lgkmcnt(0)
    v_add_f32 v96, v96, v98
    v_add_f32 v96, v96, v99
    v_add_f32 v96, v96, v100
    v_add_f32 v96, v96, v101
    v_add_f32 v96, v96, v102
    v_add_f32 v96, v96, v103
    v_add_f32 v96, v96, v104
    v_add_f32 v96, v96, v105
    v_cvt_pk_bf16_f32 v96, v96, v96
    v_lshlrev_b32 v96, 16, v96
    s_mul_i32 s26, s22, 768
    s_lshl_b32 s27, s23, 7
    s_add_u32 s26, s26, s27
    s_add_u32 s26, s26, 5267456
    v_lshlrev_b32 v1, 2, v0
    v_add_u32 v1, s26, v1
    v_cmp_gt_u32 vcc, 32, v0
    s_and_saveexec_b64 s[26:27], vcc
    buffer_store_dword v96, v1, s[12:15], 0 offen
    s_endpgm
K4_A:
    s_sub_u32 s22, s2, 192
    s_mul_i32 s24, s22, 784*8
    s_add_u32 s24, s24, 131072
    v_lshlrev_b32 v1, 2, v0
    v_add_u32 v5, s24, v1
    v_mov_b32 v2, s24
    s_waitcnt lgkmcnt(0)
    s_mov_b32 s25, 0
    buffer_load_dwordx2 v[16:17], v2, s[12:15], s25 offen offset:768
    buffer_load_dword v64, v5, s[12:15], s25 offen
    s_mov_b32 s25, 784
    buffer_load_dwordx2 v[18:19], v2, s[12:15], s25 offen offset:768
    buffer_load_dword v65, v5, s[12:15], s25 offen
    s_mov_b32 s25, 1568
    buffer_load_dwordx2 v[20:21], v2, s[12:15], s25 offen offset:768
    buffer_load_dword v66, v5, s[12:15], s25 offen
    s_mov_b32 s25, 2352
    buffer_load_dwordx2 v[22:23], v2, s[12:15], s25 offen offset:768
    buffer_load_dword v67, v5, s[12:15], s25 offen
    s_mov_b32 s25, 3136
    buffer_load_dwordx2 v[24:25], v2, s[12:15], s25 offen offset:768
    buffer_load_dword v68, v5, s[12:15], s25 offen
    s_mov_b32 s25, 3920
    buffer_load_dwordx2 v[26:27], v2, s[12:15], s25 offen offset:768
    buffer_load_dword v69, v5, s[12:15], s25 offen
    s_mov_b32 s25, 4704
    buffer_load_dwordx2 v[28:29], v2, s[12:15], s25 offen offset:768
    buffer_load_dword v70, v5, s[12:15], s25 offen
    s_mov_b32 s25, 5488
    buffer_load_dwordx2 v[30:31], v2, s[12:15], s25 offen offset:768
    buffer_load_dword v71, v5, s[12:15], s25 offen
    s_waitcnt vmcnt(0)
    v_mov_b32 v3, v16
    v_max_f32 v3, v3, v18
    v_max_f32 v3, v3, v20
    v_max_f32 v3, v3, v22
    v_max_f32 v3, v3, v24
    v_max_f32 v3, v3, v26
    v_max_f32 v3, v3, v28
    v_max_f32 v3, v3, v30
    v_mov_b32 v4, 0
    v_mov_b32 v6, 0
    v_sub_f32 v16, v16, v3
    v_exp_f32 v16, v16
    s_nop 0
    v_fmac_f32 v4, v16, v17
    v_fmac_f32 v6, v16, v64
    v_sub_f32 v18, v18, v3
    v_exp_f32 v18, v18
    s_nop 0
    v_fmac_f32 v4, v18, v19
    v_fmac_f32 v6, v18, v65
    v_sub_f32 v20, v20, v3
    v_exp_f32 v20, v20
    s_nop 0
    v_fmac_f32 v4, v20, v21
    v_fmac_f32 v6, v20, v66
    v_sub_f32 v22, v22, v3
    v_exp_f32 v22, v22
    s_nop 0
    v_fmac_f32 v4, v22, v23
    v_fmac_f32 v6, v22, v67
    v_sub_f32 v24, v24, v3
    v_exp_f32 v24, v24
    s_nop 0
    v_fmac_f32 v4, v24, v25
    v_fmac_f32 v6, v24, v68
    v_sub_f32 v26, v26, v3
    v_exp_f32 v26, v26
    s_nop 0
    v_fmac_f32 v4, v26, v27
    v_fmac_f32 v6, v26, v69
    v_sub_f32 v28, v28, v3
    v_exp_f32 v28, v28
    s_nop 0
    v_fmac_f32 v4, v28, v29
    v_fmac_f32 v6, v28, v70
    v_sub_f32 v30, v30, v3
    v_exp_f32 v30, v30
    s_nop 0
    v_fmac_f32 v4, v30, v31
    v_fmac_f32 v6, v30, v71
    v_rcp_f32 v4, v4
    s_nop 0
    v_mul_f32 v6, v6, v4
    v_cvt_pk_bf16_f32 v6, v6, v6
    v_lshlrev_b32 v6, 16, v6
    s_mul_i32 s26, s22, 768
    s_add_u32 s26, s26, 5242880
    v_add_u32 v1, s26, v1
    v_cmp_gt_u32 vcc, 192, v0
    s_and_saveexec_b64 s[26:27], vcc
    buffer_store_dword v6, v1, s[12:15], 0 offen
K4_END:
    s_endpgm
.p2align 8
.type oproj_kernel,@function
oproj_kernel:
    s_cmp_ge_u32 s2, 160
    s_cbranch_scc1 K5_END
    s_load_dwordx2 s[12:13], s[0:1], 104
    s_mov_b32 s14, 402653184
    s_mov_b32 s15, 0x00020000
    s_cmp_ge_u32 s2, 80
    s_cbranch_scc1 K5_B
    s_load_dwordx2 s[8:9], s[0:1], 32
    s_mov_b32 s20, s2
    s_mov_b32 s21, 0
    s_branch K5_GO
K5_B:
    s_load_dwordx2 s[8:9], s[0:1], 80
    s_sub_u32 s20, s2, 80
    s_mov_b32 s21, 1
K5_GO:
    s_mov_b32 s10, 7864320
    s_mov_b32 s11, 0x00020000
    s_mov_b32 s22, 0x33333334
    s_mul_hi_u32 s22, s20, s22
    s_mul_i32 s23, s22, 5
    s_sub_u32 s23, s20, s23
    s_mul_i32 s24, s21, 24576
    s_mul_i32 s25, s22, 1536
    s_add_u32 s24, s24, s25
    s_add_u32 s24, s24, 5242880
    v_lshlrev_b32 v1, 2, v0
    v_add_u32 v2, s24, v1
    s_waitcnt lgkmcnt(0)
    buffer_load_dword v3, v2, s[12:15], 0 offen
    buffer_load_dword v4, v2, s[12:15], 0 offen offset:1024
    s_waitcnt vmcnt(0)
    ds_write_b32 v1, v3
    ds_write_b32 v1, v4 offset:1024
    s_waitcnt lgkmcnt(0)
    s_barrier
    v_lshrrev_b32 v6, 4, v0
    v_lshlrev_b32 v7, 2, v6
    s_mov_b32 s26, 1280
    v_mul_lo_u32 v8, v6, s26
    v_and_b32 v9, 15, v0
    v_lshlrev_b32 v9, 4, v9
    v_add_u32 v8, v8, v9
    s_mul_i32 s26, s22, 384*1280
    s_lshl_b32 s27, s23, 8
    s_add_u32 s26, s26, s27
    v_add_u32 v8, s26, v8
    s_mov_b32 s28, 0
    buffer_load_dwordx4 v[32:35], v8, s[8:11], s28 offen
    s_add_u32 s28, s28, 20480
    buffer_load_dwordx4 v[36:39], v8, s[8:11], s28 offen
    s_add_u32 s28, s28, 20480
    buffer_load_dwordx4 v[40:43], v8, s[8:11], s28 offen
    s_add_u32 s28, s28, 20480
    buffer_load_dwordx4 v[44:47], v8, s[8:11], s28 offen
    s_add_u32 s28, s28, 20480
    buffer_load_dwordx4 v[48:51], v8, s[8:11], s28 offen
    s_add_u32 s28, s28, 20480
    buffer_load_dwordx4 v[52:55], v8, s[8:11], s28 offen
    s_add_u32 s28, s28, 20480
    buffer_load_dwordx4 v[56:59], v8, s[8:11], s28 offen
    s_add_u32 s28, s28, 20480
    buffer_load_dwordx4 v[60:63], v8, s[8:11], s28 offen
    s_add_u32 s28, s28, 20480
    buffer_load_dwordx4 v[64:67], v8, s[8:11], s28 offen
    s_add_u32 s28, s28, 20480
    buffer_load_dwordx4 v[68:71], v8, s[8:11], s28 offen
    s_add_u32 s28, s28, 20480
    buffer_load_dwordx4 v[72:75], v8, s[8:11], s28 offen
    s_add_u32 s28, s28, 20480
    buffer_load_dwordx4 v[76:79], v8, s[8:11], s28 offen
    s_add_u32 s28, s28, 20480
    buffer_load_dwordx4 v[80:83], v8, s[8:11], s28 offen
    s_add_u32 s28, s28, 20480
    buffer_load_dwordx4 v[84:87], v8, s[8:11], s28 offen
    s_add_u32 s28, s28, 20480
    buffer_load_dwordx4 v[88:91], v8, s[8:11], s28 offen
    s_add_u32 s28, s28, 20480
    buffer_load_dwordx4 v[92:95], v8, s[8:11], s28 offen
    s_add_u32 s28, s28, 20480
    buffer_load_dwordx4 v[96:99], v8, s[8:11], s28 offen
    s_add_u32 s28, s28, 20480
    buffer_load_dwordx4 v[100:103], v8, s[8:11], s28 offen
    s_add_u32 s28, s28, 20480
    buffer_load_dwordx4 v[104:107], v8, s[8:11], s28 offen
    s_add_u32 s28, s28, 20480
    buffer_load_dwordx4 v[108:111], v8, s[8:11], s28 offen
    s_add_u32 s28, s28, 20480
    buffer_load_dwordx4 v[112:115], v8, s[8:11], s28 offen
    s_add_u32 s28, s28, 20480
    buffer_load_dwordx4 v[116:119], v8, s[8:11], s28 offen
    s_add_u32 s28, s28, 20480
    buffer_load_dwordx4 v[120:123], v8, s[8:11], s28 offen
    s_add_u32 s28, s28, 20480
    buffer_load_dwordx4 v[124:127], v8, s[8:11], s28 offen
    v_mov_b32 v16, 0
    v_mov_b32 v17, 0
    v_mov_b32 v18, 0
    v_mov_b32 v19, 0
    v_mov_b32 v20, 0
    v_mov_b32 v21, 0
    v_mov_b32 v22, 0
    v_mov_b32 v23, 0
    ds_read_b32 v128, v7 offset:0
    s_waitcnt vmcnt(23) lgkmcnt(0)
    v_lshlrev_b32 v129, 16, v32
    v_and_b32 v130, 0xffff0000, v32
    v_fmac_f32 v16, v128, v129
    v_fmac_f32 v17, v128, v130
    v_lshlrev_b32 v129, 16, v33
    v_and_b32 v130, 0xffff0000, v33
    v_fmac_f32 v18, v128, v129
    v_fmac_f32 v19, v128, v130
    v_lshlrev_b32 v129, 16, v34
    v_and_b32 v130, 0xffff0000, v34
    v_fmac_f32 v20, v128, v129
    v_fmac_f32 v21, v128, v130
    v_lshlrev_b32 v129, 16, v35
    v_and_b32 v130, 0xffff0000, v35
    v_fmac_f32 v22, v128, v129
    v_fmac_f32 v23, v128, v130
    ds_read_b32 v128, v7 offset:64
    s_waitcnt vmcnt(22) lgkmcnt(0)
    v_lshlrev_b32 v129, 16, v36
    v_and_b32 v130, 0xffff0000, v36
    v_fmac_f32 v16, v128, v129
    v_fmac_f32 v17, v128, v130
    v_lshlrev_b32 v129, 16, v37
    v_and_b32 v130, 0xffff0000, v37
    v_fmac_f32 v18, v128, v129
    v_fmac_f32 v19, v128, v130
    v_lshlrev_b32 v129, 16, v38
    v_and_b32 v130, 0xffff0000, v38
    v_fmac_f32 v20, v128, v129
    v_fmac_f32 v21, v128, v130
    v_lshlrev_b32 v129, 16, v39
    v_and_b32 v130, 0xffff0000, v39
    v_fmac_f32 v22, v128, v129
    v_fmac_f32 v23, v128, v130
    ds_read_b32 v128, v7 offset:128
    s_waitcnt vmcnt(21) lgkmcnt(0)
    v_lshlrev_b32 v129, 16, v40
    v_and_b32 v130, 0xffff0000, v40
    v_fmac_f32 v16, v128, v129
    v_fmac_f32 v17, v128, v130
    v_lshlrev_b32 v129, 16, v41
    v_and_b32 v130, 0xffff0000, v41
    v_fmac_f32 v18, v128, v129
    v_fmac_f32 v19, v128, v130
    v_lshlrev_b32 v129, 16, v42
    v_and_b32 v130, 0xffff0000, v42
    v_fmac_f32 v20, v128, v129
    v_fmac_f32 v21, v128, v130
    v_lshlrev_b32 v129, 16, v43
    v_and_b32 v130, 0xffff0000, v43
    v_fmac_f32 v22, v128, v129
    v_fmac_f32 v23, v128, v130
    ds_read_b32 v128, v7 offset:192
    s_waitcnt vmcnt(20) lgkmcnt(0)
    v_lshlrev_b32 v129, 16, v44
    v_and_b32 v130, 0xffff0000, v44
    v_fmac_f32 v16, v128, v129
    v_fmac_f32 v17, v128, v130
    v_lshlrev_b32 v129, 16, v45
    v_and_b32 v130, 0xffff0000, v45
    v_fmac_f32 v18, v128, v129
    v_fmac_f32 v19, v128, v130
    v_lshlrev_b32 v129, 16, v46
    v_and_b32 v130, 0xffff0000, v46
    v_fmac_f32 v20, v128, v129
    v_fmac_f32 v21, v128, v130
    v_lshlrev_b32 v129, 16, v47
    v_and_b32 v130, 0xffff0000, v47
    v_fmac_f32 v22, v128, v129
    v_fmac_f32 v23, v128, v130
    ds_read_b32 v128, v7 offset:256
    s_waitcnt vmcnt(19) lgkmcnt(0)
    v_lshlrev_b32 v129, 16, v48
    v_and_b32 v130, 0xffff0000, v48
    v_fmac_f32 v16, v128, v129
    v_fmac_f32 v17, v128, v130
    v_lshlrev_b32 v129, 16, v49
    v_and_b32 v130, 0xffff0000, v49
    v_fmac_f32 v18, v128, v129
    v_fmac_f32 v19, v128, v130
    v_lshlrev_b32 v129, 16, v50
    v_and_b32 v130, 0xffff0000, v50
    v_fmac_f32 v20, v128, v129
    v_fmac_f32 v21, v128, v130
    v_lshlrev_b32 v129, 16, v51
    v_and_b32 v130, 0xffff0000, v51
    v_fmac_f32 v22, v128, v129
    v_fmac_f32 v23, v128, v130
    ds_read_b32 v128, v7 offset:320
    s_waitcnt vmcnt(18) lgkmcnt(0)
    v_lshlrev_b32 v129, 16, v52
    v_and_b32 v130, 0xffff0000, v52
    v_fmac_f32 v16, v128, v129
    v_fmac_f32 v17, v128, v130
    v_lshlrev_b32 v129, 16, v53
    v_and_b32 v130, 0xffff0000, v53
    v_fmac_f32 v18, v128, v129
    v_fmac_f32 v19, v128, v130
    v_lshlrev_b32 v129, 16, v54
    v_and_b32 v130, 0xffff0000, v54
    v_fmac_f32 v20, v128, v129
    v_fmac_f32 v21, v128, v130
    v_lshlrev_b32 v129, 16, v55
    v_and_b32 v130, 0xffff0000, v55
    v_fmac_f32 v22, v128, v129
    v_fmac_f32 v23, v128, v130
    ds_read_b32 v128, v7 offset:384
    s_waitcnt vmcnt(17) lgkmcnt(0)
    v_lshlrev_b32 v129, 16, v56
    v_and_b32 v130, 0xffff0000, v56
    v_fmac_f32 v16, v128, v129
    v_fmac_f32 v17, v128, v130
    v_lshlrev_b32 v129, 16, v57
    v_and_b32 v130, 0xffff0000, v57
    v_fmac_f32 v18, v128, v129
    v_fmac_f32 v19, v128, v130
    v_lshlrev_b32 v129, 16, v58
    v_and_b32 v130, 0xffff0000, v58
    v_fmac_f32 v20, v128, v129
    v_fmac_f32 v21, v128, v130
    v_lshlrev_b32 v129, 16, v59
    v_and_b32 v130, 0xffff0000, v59
    v_fmac_f32 v22, v128, v129
    v_fmac_f32 v23, v128, v130
    ds_read_b32 v128, v7 offset:448
    s_waitcnt vmcnt(16) lgkmcnt(0)
    v_lshlrev_b32 v129, 16, v60
    v_and_b32 v130, 0xffff0000, v60
    v_fmac_f32 v16, v128, v129
    v_fmac_f32 v17, v128, v130
    v_lshlrev_b32 v129, 16, v61
    v_and_b32 v130, 0xffff0000, v61
    v_fmac_f32 v18, v128, v129
    v_fmac_f32 v19, v128, v130
    v_lshlrev_b32 v129, 16, v62
    v_and_b32 v130, 0xffff0000, v62
    v_fmac_f32 v20, v128, v129
    v_fmac_f32 v21, v128, v130
    v_lshlrev_b32 v129, 16, v63
    v_and_b32 v130, 0xffff0000, v63
    v_fmac_f32 v22, v128, v129
    v_fmac_f32 v23, v128, v130
    ds_read_b32 v128, v7 offset:512
    s_waitcnt vmcnt(15) lgkmcnt(0)
    v_lshlrev_b32 v129, 16, v64
    v_and_b32 v130, 0xffff0000, v64
    v_fmac_f32 v16, v128, v129
    v_fmac_f32 v17, v128, v130
    v_lshlrev_b32 v129, 16, v65
    v_and_b32 v130, 0xffff0000, v65
    v_fmac_f32 v18, v128, v129
    v_fmac_f32 v19, v128, v130
    v_lshlrev_b32 v129, 16, v66
    v_and_b32 v130, 0xffff0000, v66
    v_fmac_f32 v20, v128, v129
    v_fmac_f32 v21, v128, v130
    v_lshlrev_b32 v129, 16, v67
    v_and_b32 v130, 0xffff0000, v67
    v_fmac_f32 v22, v128, v129
    v_fmac_f32 v23, v128, v130
    ds_read_b32 v128, v7 offset:576
    s_waitcnt vmcnt(14) lgkmcnt(0)
    v_lshlrev_b32 v129, 16, v68
    v_and_b32 v130, 0xffff0000, v68
    v_fmac_f32 v16, v128, v129
    v_fmac_f32 v17, v128, v130
    v_lshlrev_b32 v129, 16, v69
    v_and_b32 v130, 0xffff0000, v69
    v_fmac_f32 v18, v128, v129
    v_fmac_f32 v19, v128, v130
    v_lshlrev_b32 v129, 16, v70
    v_and_b32 v130, 0xffff0000, v70
    v_fmac_f32 v20, v128, v129
    v_fmac_f32 v21, v128, v130
    v_lshlrev_b32 v129, 16, v71
    v_and_b32 v130, 0xffff0000, v71
    v_fmac_f32 v22, v128, v129
    v_fmac_f32 v23, v128, v130
    ds_read_b32 v128, v7 offset:640
    s_waitcnt vmcnt(13) lgkmcnt(0)
    v_lshlrev_b32 v129, 16, v72
    v_and_b32 v130, 0xffff0000, v72
    v_fmac_f32 v16, v128, v129
    v_fmac_f32 v17, v128, v130
    v_lshlrev_b32 v129, 16, v73
    v_and_b32 v130, 0xffff0000, v73
    v_fmac_f32 v18, v128, v129
    v_fmac_f32 v19, v128, v130
    v_lshlrev_b32 v129, 16, v74
    v_and_b32 v130, 0xffff0000, v74
    v_fmac_f32 v20, v128, v129
    v_fmac_f32 v21, v128, v130
    v_lshlrev_b32 v129, 16, v75
    v_and_b32 v130, 0xffff0000, v75
    v_fmac_f32 v22, v128, v129
    v_fmac_f32 v23, v128, v130
    ds_read_b32 v128, v7 offset:704
    s_waitcnt vmcnt(12) lgkmcnt(0)
    v_lshlrev_b32 v129, 16, v76
    v_and_b32 v130, 0xffff0000, v76
    v_fmac_f32 v16, v128, v129
    v_fmac_f32 v17, v128, v130
    v_lshlrev_b32 v129, 16, v77
    v_and_b32 v130, 0xffff0000, v77
    v_fmac_f32 v18, v128, v129
    v_fmac_f32 v19, v128, v130
    v_lshlrev_b32 v129, 16, v78
    v_and_b32 v130, 0xffff0000, v78
    v_fmac_f32 v20, v128, v129
    v_fmac_f32 v21, v128, v130
    v_lshlrev_b32 v129, 16, v79
    v_and_b32 v130, 0xffff0000, v79
    v_fmac_f32 v22, v128, v129
    v_fmac_f32 v23, v128, v130
    ds_read_b32 v128, v7 offset:768
    s_waitcnt vmcnt(11) lgkmcnt(0)
    v_lshlrev_b32 v129, 16, v80
    v_and_b32 v130, 0xffff0000, v80
    v_fmac_f32 v16, v128, v129
    v_fmac_f32 v17, v128, v130
    v_lshlrev_b32 v129, 16, v81
    v_and_b32 v130, 0xffff0000, v81
    v_fmac_f32 v18, v128, v129
    v_fmac_f32 v19, v128, v130
    v_lshlrev_b32 v129, 16, v82
    v_and_b32 v130, 0xffff0000, v82
    v_fmac_f32 v20, v128, v129
    v_fmac_f32 v21, v128, v130
    v_lshlrev_b32 v129, 16, v83
    v_and_b32 v130, 0xffff0000, v83
    v_fmac_f32 v22, v128, v129
    v_fmac_f32 v23, v128, v130
    ds_read_b32 v128, v7 offset:832
    s_waitcnt vmcnt(10) lgkmcnt(0)
    v_lshlrev_b32 v129, 16, v84
    v_and_b32 v130, 0xffff0000, v84
    v_fmac_f32 v16, v128, v129
    v_fmac_f32 v17, v128, v130
    v_lshlrev_b32 v129, 16, v85
    v_and_b32 v130, 0xffff0000, v85
    v_fmac_f32 v18, v128, v129
    v_fmac_f32 v19, v128, v130
    v_lshlrev_b32 v129, 16, v86
    v_and_b32 v130, 0xffff0000, v86
    v_fmac_f32 v20, v128, v129
    v_fmac_f32 v21, v128, v130
    v_lshlrev_b32 v129, 16, v87
    v_and_b32 v130, 0xffff0000, v87
    v_fmac_f32 v22, v128, v129
    v_fmac_f32 v23, v128, v130
    ds_read_b32 v128, v7 offset:896
    s_waitcnt vmcnt(9) lgkmcnt(0)
    v_lshlrev_b32 v129, 16, v88
    v_and_b32 v130, 0xffff0000, v88
    v_fmac_f32 v16, v128, v129
    v_fmac_f32 v17, v128, v130
    v_lshlrev_b32 v129, 16, v89
    v_and_b32 v130, 0xffff0000, v89
    v_fmac_f32 v18, v128, v129
    v_fmac_f32 v19, v128, v130
    v_lshlrev_b32 v129, 16, v90
    v_and_b32 v130, 0xffff0000, v90
    v_fmac_f32 v20, v128, v129
    v_fmac_f32 v21, v128, v130
    v_lshlrev_b32 v129, 16, v91
    v_and_b32 v130, 0xffff0000, v91
    v_fmac_f32 v22, v128, v129
    v_fmac_f32 v23, v128, v130
    ds_read_b32 v128, v7 offset:960
    s_waitcnt vmcnt(8) lgkmcnt(0)
    v_lshlrev_b32 v129, 16, v92
    v_and_b32 v130, 0xffff0000, v92
    v_fmac_f32 v16, v128, v129
    v_fmac_f32 v17, v128, v130
    v_lshlrev_b32 v129, 16, v93
    v_and_b32 v130, 0xffff0000, v93
    v_fmac_f32 v18, v128, v129
    v_fmac_f32 v19, v128, v130
    v_lshlrev_b32 v129, 16, v94
    v_and_b32 v130, 0xffff0000, v94
    v_fmac_f32 v20, v128, v129
    v_fmac_f32 v21, v128, v130
    v_lshlrev_b32 v129, 16, v95
    v_and_b32 v130, 0xffff0000, v95
    v_fmac_f32 v22, v128, v129
    v_fmac_f32 v23, v128, v130
    ds_read_b32 v128, v7 offset:1024
    s_waitcnt vmcnt(7) lgkmcnt(0)
    v_lshlrev_b32 v129, 16, v96
    v_and_b32 v130, 0xffff0000, v96
    v_fmac_f32 v16, v128, v129
    v_fmac_f32 v17, v128, v130
    v_lshlrev_b32 v129, 16, v97
    v_and_b32 v130, 0xffff0000, v97
    v_fmac_f32 v18, v128, v129
    v_fmac_f32 v19, v128, v130
    v_lshlrev_b32 v129, 16, v98
    v_and_b32 v130, 0xffff0000, v98
    v_fmac_f32 v20, v128, v129
    v_fmac_f32 v21, v128, v130
    v_lshlrev_b32 v129, 16, v99
    v_and_b32 v130, 0xffff0000, v99
    v_fmac_f32 v22, v128, v129
    v_fmac_f32 v23, v128, v130
    ds_read_b32 v128, v7 offset:1088
    s_waitcnt vmcnt(6) lgkmcnt(0)
    v_lshlrev_b32 v129, 16, v100
    v_and_b32 v130, 0xffff0000, v100
    v_fmac_f32 v16, v128, v129
    v_fmac_f32 v17, v128, v130
    v_lshlrev_b32 v129, 16, v101
    v_and_b32 v130, 0xffff0000, v101
    v_fmac_f32 v18, v128, v129
    v_fmac_f32 v19, v128, v130
    v_lshlrev_b32 v129, 16, v102
    v_and_b32 v130, 0xffff0000, v102
    v_fmac_f32 v20, v128, v129
    v_fmac_f32 v21, v128, v130
    v_lshlrev_b32 v129, 16, v103
    v_and_b32 v130, 0xffff0000, v103
    v_fmac_f32 v22, v128, v129
    v_fmac_f32 v23, v128, v130
    ds_read_b32 v128, v7 offset:1152
    s_waitcnt vmcnt(5) lgkmcnt(0)
    v_lshlrev_b32 v129, 16, v104
    v_and_b32 v130, 0xffff0000, v104
    v_fmac_f32 v16, v128, v129
    v_fmac_f32 v17, v128, v130
    v_lshlrev_b32 v129, 16, v105
    v_and_b32 v130, 0xffff0000, v105
    v_fmac_f32 v18, v128, v129
    v_fmac_f32 v19, v128, v130
    v_lshlrev_b32 v129, 16, v106
    v_and_b32 v130, 0xffff0000, v106
    v_fmac_f32 v20, v128, v129
    v_fmac_f32 v21, v128, v130
    v_lshlrev_b32 v129, 16, v107
    v_and_b32 v130, 0xffff0000, v107
    v_fmac_f32 v22, v128, v129
    v_fmac_f32 v23, v128, v130
    ds_read_b32 v128, v7 offset:1216
    s_waitcnt vmcnt(4) lgkmcnt(0)
    v_lshlrev_b32 v129, 16, v108
    v_and_b32 v130, 0xffff0000, v108
    v_fmac_f32 v16, v128, v129
    v_fmac_f32 v17, v128, v130
    v_lshlrev_b32 v129, 16, v109
    v_and_b32 v130, 0xffff0000, v109
    v_fmac_f32 v18, v128, v129
    v_fmac_f32 v19, v128, v130
    v_lshlrev_b32 v129, 16, v110
    v_and_b32 v130, 0xffff0000, v110
    v_fmac_f32 v20, v128, v129
    v_fmac_f32 v21, v128, v130
    v_lshlrev_b32 v129, 16, v111
    v_and_b32 v130, 0xffff0000, v111
    v_fmac_f32 v22, v128, v129
    v_fmac_f32 v23, v128, v130
    ds_read_b32 v128, v7 offset:1280
    s_waitcnt vmcnt(3) lgkmcnt(0)
    v_lshlrev_b32 v129, 16, v112
    v_and_b32 v130, 0xffff0000, v112
    v_fmac_f32 v16, v128, v129
    v_fmac_f32 v17, v128, v130
    v_lshlrev_b32 v129, 16, v113
    v_and_b32 v130, 0xffff0000, v113
    v_fmac_f32 v18, v128, v129
    v_fmac_f32 v19, v128, v130
    v_lshlrev_b32 v129, 16, v114
    v_and_b32 v130, 0xffff0000, v114
    v_fmac_f32 v20, v128, v129
    v_fmac_f32 v21, v128, v130
    v_lshlrev_b32 v129, 16, v115
    v_and_b32 v130, 0xffff0000, v115
    v_fmac_f32 v22, v128, v129
    v_fmac_f32 v23, v128, v130
    ds_read_b32 v128, v7 offset:1344
    s_waitcnt vmcnt(2) lgkmcnt(0)
    v_lshlrev_b32 v129, 16, v116
    v_and_b32 v130, 0xffff0000, v116
    v_fmac_f32 v16, v128, v129
    v_fmac_f32 v17, v128, v130
    v_lshlrev_b32 v129, 16, v117
    v_and_b32 v130, 0xffff0000, v117
    v_fmac_f32 v18, v128, v129
    v_fmac_f32 v19, v128, v130
    v_lshlrev_b32 v129, 16, v118
    v_and_b32 v130, 0xffff0000, v118
    v_fmac_f32 v20, v128, v129
    v_fmac_f32 v21, v128, v130
    v_lshlrev_b32 v129, 16, v119
    v_and_b32 v130, 0xffff0000, v119
    v_fmac_f32 v22, v128, v129
    v_fmac_f32 v23, v128, v130
    ds_read_b32 v128, v7 offset:1408
    s_waitcnt vmcnt(1) lgkmcnt(0)
    v_lshlrev_b32 v129, 16, v120
    v_and_b32 v130, 0xffff0000, v120
    v_fmac_f32 v16, v128, v129
    v_fmac_f32 v17, v128, v130
    v_lshlrev_b32 v129, 16, v121
    v_and_b32 v130, 0xffff0000, v121
    v_fmac_f32 v18, v128, v129
    v_fmac_f32 v19, v128, v130
    v_lshlrev_b32 v129, 16, v122
    v_and_b32 v130, 0xffff0000, v122
    v_fmac_f32 v20, v128, v129
    v_fmac_f32 v21, v128, v130
    v_lshlrev_b32 v129, 16, v123
    v_and_b32 v130, 0xffff0000, v123
    v_fmac_f32 v22, v128, v129
    v_fmac_f32 v23, v128, v130
    ds_read_b32 v128, v7 offset:1472
    s_waitcnt vmcnt(0) lgkmcnt(0)
    v_lshlrev_b32 v129, 16, v124
    v_and_b32 v130, 0xffff0000, v124
    v_fmac_f32 v16, v128, v129
    v_fmac_f32 v17, v128, v130
    v_lshlrev_b32 v129, 16, v125
    v_and_b32 v130, 0xffff0000, v125
    v_fmac_f32 v18, v128, v129
    v_fmac_f32 v19, v128, v130
    v_lshlrev_b32 v129, 16, v126
    v_and_b32 v130, 0xffff0000, v126
    v_fmac_f32 v20, v128, v129
    v_fmac_f32 v21, v128, v130
    v_lshlrev_b32 v129, 16, v127
    v_and_b32 v130, 0xffff0000, v127
    v_fmac_f32 v22, v128, v129
    v_fmac_f32 v23, v128, v130
    v_lshlrev_b32 v128, 5, v0
    ds_write_b128 v128, v[16:19] offset:4096
    ds_write_b128 v128, v[20:23] offset:4112
    s_waitcnt lgkmcnt(0)
    s_barrier
    v_lshlrev_b32 v129, 2, v0
    v_mov_b32 v128, 0
    v_min_u32 v129, 508, v129
    ds_read_b32 v130, v129 offset:4096
    ds_read_b32 v131, v129 offset:4608
    ds_read_b32 v132, v129 offset:5120
    ds_read_b32 v133, v129 offset:5632
    ds_read_b32 v134, v129 offset:6144
    ds_read_b32 v135, v129 offset:6656
    ds_read_b32 v136, v129 offset:7168
    ds_read_b32 v137, v129 offset:7680
    s_waitcnt lgkmcnt(0)
    v_add_f32 v128, v128, v130
    v_add_f32 v128, v128, v131
    v_add_f32 v128, v128, v132
    v_add_f32 v128, v128, v133
    v_add_f32 v128, v128, v134
    v_add_f32 v128, v128, v135
    v_add_f32 v128, v128, v136
    v_add_f32 v128, v128, v137
    ds_read_b32 v130, v129 offset:8192
    ds_read_b32 v131, v129 offset:8704
    ds_read_b32 v132, v129 offset:9216
    ds_read_b32 v133, v129 offset:9728
    ds_read_b32 v134, v129 offset:10240
    ds_read_b32 v135, v129 offset:10752
    ds_read_b32 v136, v129 offset:11264
    ds_read_b32 v137, v129 offset:11776
    s_waitcnt lgkmcnt(0)
    v_add_f32 v128, v128, v130
    v_add_f32 v128, v128, v131
    v_add_f32 v128, v128, v132
    v_add_f32 v128, v128, v133
    v_add_f32 v128, v128, v134
    v_add_f32 v128, v128, v135
    v_add_f32 v128, v128, v136
    v_add_f32 v128, v128, v137
    s_mul_i32 s26, s22, 5120
    s_mul_i32 s27, s21, 2560
    s_add_u32 s26, s26, s27
    s_lshl_b32 s27, s23, 9
    s_add_u32 s26, s26, s27
    s_add_u32 s26, s26, 6291456
    v_lshlrev_b32 v1, 2, v0
    v_add_u32 v1, s26, v1
    v_cmp_gt_u32 vcc, 128, v0
    s_and_saveexec_b64 s[26:27], vcc
    buffer_store_dword v128, v1, s[12:15], 0 offen
K5_END:
    s_endpgm
.p2align 8
.type final_kernel,@function
final_kernel:
    s_cmp_ge_u32 s2, 5
    s_cbranch_scc1 K6_END
    s_load_dwordx2 s[12:13], s[0:1], 104
    s_mov_b32 s14, 402653184
    s_mov_b32 s15, 0x00020000
    s_load_dwordx2 s[8:9], s[0:1], 88
    s_mov_b32 s10, 2560
    s_mov_b32 s11, 0x00020000
    s_lshl_b32 s20, s2, 8
    v_add_u32 v1, s20, v0
    v_lshlrev_b32 v2, 2, v1
    v_add_u32 v2, 6291456, v2
    s_waitcnt lgkmcnt(0)
    s_mov_b32 s25, 0
    buffer_load_dword v16, v2, s[12:15], s25 offen
    s_mov_b32 s25, 5120
    buffer_load_dword v17, v2, s[12:15], s25 offen
    s_mov_b32 s25, 10240
    buffer_load_dword v18, v2, s[12:15], s25 offen
    s_mov_b32 s25, 15360
    buffer_load_dword v19, v2, s[12:15], s25 offen
    s_mov_b32 s25, 20480
    buffer_load_dword v20, v2, s[12:15], s25 offen
    s_mov_b32 s25, 25600
    buffer_load_dword v21, v2, s[12:15], s25 offen
    s_mov_b32 s25, 30720
    buffer_load_dword v22, v2, s[12:15], s25 offen
    s_mov_b32 s25, 35840
    buffer_load_dword v23, v2, s[12:15], s25 offen
    s_mov_b32 s25, 40960
    buffer_load_dword v24, v2, s[12:15], s25 offen
    s_mov_b32 s25, 46080
    buffer_load_dword v25, v2, s[12:15], s25 offen
    s_mov_b32 s25, 51200
    buffer_load_dword v26, v2, s[12:15], s25 offen
    s_mov_b32 s25, 56320
    buffer_load_dword v27, v2, s[12:15], s25 offen
    s_mov_b32 s25, 61440
    buffer_load_dword v28, v2, s[12:15], s25 offen
    s_mov_b32 s25, 66560
    buffer_load_dword v29, v2, s[12:15], s25 offen
    s_mov_b32 s25, 71680
    buffer_load_dword v30, v2, s[12:15], s25 offen
    s_mov_b32 s25, 76800
    buffer_load_dword v31, v2, s[12:15], s25 offen
    s_waitcnt vmcnt(0)
    v_add_f32 v16, v16, v17
    v_add_f32 v16, v16, v18
    v_add_f32 v16, v16, v19
    v_add_f32 v16, v16, v20
    v_add_f32 v16, v16, v21
    v_add_f32 v16, v16, v22
    v_add_f32 v16, v16, v23
    v_add_f32 v16, v16, v24
    v_add_f32 v16, v16, v25
    v_add_f32 v16, v16, v26
    v_add_f32 v16, v16, v27
    v_add_f32 v16, v16, v28
    v_add_f32 v16, v16, v29
    v_add_f32 v16, v16, v30
    v_add_f32 v16, v16, v31
    v_cvt_pk_bf16_f32 v16, v16, v16
    v_lshlrev_b32 v1, 1, v1
    buffer_store_short v16, v1, s[8:11], 0 offen
K6_END:
    s_endpgm
.section .rodata,"a"
.p2align 6
.amdhsa_kernel qproj_kernel
  .amdhsa_next_free_vgpr 96
  .amdhsa_next_free_sgpr 102
  .amdhsa_accum_offset 96
  .amdhsa_group_segment_fixed_size 0
  .amdhsa_kernarg_size 112
  .amdhsa_user_sgpr_count 2
  .amdhsa_user_sgpr_kernarg_segment_ptr 1
  .amdhsa_system_sgpr_workgroup_id_x 1
.end_amdhsa_kernel
.p2align 6
.amdhsa_kernel qabs_kernel
  .amdhsa_next_free_vgpr 64
  .amdhsa_next_free_sgpr 102
  .amdhsa_accum_offset 64
  .amdhsa_group_segment_fixed_size 0
  .amdhsa_kernarg_size 112
  .amdhsa_user_sgpr_count 2
  .amdhsa_user_sgpr_kernarg_segment_ptr 1
  .amdhsa_system_sgpr_workgroup_id_x 1
.end_amdhsa_kernel
.p2align 6
.amdhsa_kernel attn_kernel
  .amdhsa_next_free_vgpr 256
  .amdhsa_next_free_sgpr 102
  .amdhsa_accum_offset 256
  .amdhsa_group_segment_fixed_size 0
  .amdhsa_kernarg_size 112
  .amdhsa_user_sgpr_count 2
  .amdhsa_user_sgpr_kernarg_segment_ptr 1
  .amdhsa_system_sgpr_workgroup_id_x 1
.end_amdhsa_kernel
.p2align 6
.amdhsa_kernel comb_kernel
  .amdhsa_next_free_vgpr 128
  .amdhsa_next_free_sgpr 102
  .amdhsa_accum_offset 128
  .amdhsa_group_segment_fixed_size 0
  .amdhsa_kernarg_size 112
  .amdhsa_user_sgpr_count 2
  .amdhsa_user_sgpr_kernarg_segment_ptr 1
  .amdhsa_system_sgpr_workgroup_id_x 1
.end_amdhsa_kernel
.p2align 6
.amdhsa_kernel oproj_kernel
  .amdhsa_next_free_vgpr 144
  .amdhsa_next_free_sgpr 102
  .amdhsa_accum_offset 144
  .amdhsa_group_segment_fixed_size 0
  .amdhsa_kernarg_size 112
  .amdhsa_user_sgpr_count 2
  .amdhsa_user_sgpr_kernarg_segment_ptr 1
  .amdhsa_system_sgpr_workgroup_id_x 1
.end_amdhsa_kernel
.p2align 6
.amdhsa_kernel final_kernel
  .amdhsa_next_free_vgpr 32
  .amdhsa_next_free_sgpr 102
  .amdhsa_accum_offset 32
  .amdhsa_group_segment_fixed_size 0
  .amdhsa_kernarg_size 112
  .amdhsa_user_sgpr_count 2
  .amdhsa_user_sgpr_kernarg_segment_ptr 1
  .amdhsa_system_sgpr_workgroup_id_x 1
.end_amdhsa_kernel
```
